```python
import torch

def _softmax(x, axis=-1):
    return torch.softmax(x, dim=axis)
def _gelu(x):
    return torch.nn.functional.gelu(x, approximate="tanh")
def _silu(x):
    return torch.nn.functional.silu(x)
def _sigmoid(x):
    return torch.sigmoid(x)
def _layernorm(x, axis=-1, eps=1e-5):
    m = x.mean(dim=axis, keepdim=True)
    v = x.var(dim=axis, keepdim=True, unbiased=False)
    return (x - m) / torch.sqrt(v + eps)
def _scatter_add(tgt, idx, src, axis=0):
    return tgt.clone().index_add_(axis, idx, src)
def _segment_sum(src, seg, n):
    out = torch.zeros((n,) + src.shape[1:], dtype=src.dtype)
    return out.index_add_(0, seg, src)
def _pad(x, pw):
    flat = tuple(v for pair in reversed(pw) for v in pair)
    return torch.nn.functional.pad(x, flat)

kernel_name = 'gated_mix__gqa_block_cached__glu_gated_glu__decode'

def setup_inputs():

    _w = (lambda a: (lambda t: t.to(torch.bfloat16) if t.is_floating_point() else t)(torch.as_tensor(a)))
    def _A_setup():
        B, Sq, D = 2, 1, 512
        Hq, Hkv, Sk, Dh = 32, 8, 16384, 128
        assert Hq % Hkv == 0, (Hq, Hkv)
        return {
            "x": _w((lambda *s: torch.randn(*s, dtype=torch.bfloat16) * 0.05)(B, Sq, D)),
            "k_cache": _w((lambda *s: torch.randn(*s, dtype=torch.bfloat16) * 6.4)(B, Hkv, Sk, Dh)),
            "v_cache": _w((lambda *s: torch.randn(*s, dtype=torch.bfloat16) * 1.6)(B, Hkv, Sk, Dh)),
            "wq": _w((lambda *s: torch.randn(*s, dtype=torch.bfloat16) * 6.4)(D, Hq * Dh) * (D ** -0.5)),
            "wo": _w((lambda *s: torch.randn(*s, dtype=torch.bfloat16) * 1.6)(Hq * Dh, D) * ((Hq * Dh) ** -0.5)),
        }
    _A_in = _A_setup()

    def _B_setup():
        B, S, D, F = 2, 1, 512, 1792
        return {
            "x": _w((lambda *s: torch.randn(*s, dtype=torch.bfloat16) * 0.05)(B, S, D)),
            "w_gate": _w((lambda *s: torch.randn(*s, dtype=torch.bfloat16) * 1.6)(D, F)),
            "w_up": _w((lambda *s: torch.randn(*s, dtype=torch.bfloat16) * 0.05)(D, F)),
            "w_down": _w((lambda *s: torch.randn(*s, dtype=torch.bfloat16) * 0.05)(F, D)),
        }
    _B_in = _B_setup()

    return {
        "A_x": _A_in["x"],
        "A_k_cache": _A_in["k_cache"],
        "A_v_cache": _A_in["v_cache"],
        "A_wq": _A_in["wq"],
        "A_wo": _A_in["wo"],
        "B_x": _B_in["x"],
        "B_w_gate": _B_in["w_gate"],
        "B_w_up": _B_in["w_up"],
        "B_w_down": _B_in["w_down"],
        "gate_w": _w((lambda *s: torch.randn(*s, dtype=torch.bfloat16) * 0.05)(512) * 16.0),
    }

def reference(A_x, A_k_cache, A_v_cache, A_wq, A_wo, B_x, B_w_gate, B_w_up, B_w_down, gate_w):
    def _A_ref(x, k_cache, v_cache, wq, wo):
        B, Sq, D = x.shape
        Hq, Dh = 32, 128
        Hkv = k_cache.shape[1]
        rep = Hq // Hkv
        q = (lambda x, *d: x.permute(*d))((x @ wq).reshape(B, Sq, Hq, Dh), 0, 2, 1, 3)
        k = (lambda x, n, axis: torch.repeat_interleave(x, n, dim=axis))(k_cache, rep, axis=1)
        v = (lambda x, n, axis: torch.repeat_interleave(x, n, dim=axis))(v_cache, rep, axis=1)
        scores = torch.einsum("bhqd,bhkd->bhqk", q, k) * (Dh ** -0.5)
        p = _softmax(scores, axis=-1)
        o = torch.einsum("bhqk,bhkd->bhqd", p, v)
        return (lambda x, *d: x.permute(*d))(o, 0, 2, 1, 3).reshape(B, Sq, Hq * Dh) @ wo

    def _B_ref(x, w_gate, w_up, w_down):
        g = torch.einsum("bsd,df->bsf", x, w_gate)
        u = torch.einsum("bsd,df->bsf", x, w_up)
        h = _sigmoid(g) * u
        return torch.einsum("bsf,fd->bsd", h, w_down)

    x = A_x
    g = _sigmoid((x * gate_w).sum(-1, keepdims=True))
    a = _A_ref(x, A_k_cache, A_v_cache, A_wq, A_wo)
    b = _B_ref(x, B_w_gate, B_w_up, B_w_down)
    return g * a + (1 - g) * b
```

```asm
; @launch grid=(256,1,1) block=(512,1,1) lds=64768
.amdgcn_target "amdgcn-amd-amdhsa--gfx950"
.text
.globl gated_mix__gqa_block_cached__glu_gated_glu__decode_kernel
.p2align 8
.type gated_mix__gqa_block_cached__glu_gated_glu__decode_kernel,@function
gated_mix__gqa_block_cached__glu_gated_glu__decode_kernel:
    s_cmp_ge_u32 s2, 256
    s_cbranch_scc1 L_end
    s_load_dwordx16 s[4:19], s[0:1], 0
    s_load_dwordx8 s[20:27], s[0:1], 64
    s_load_dwordx2 s[28:29], s[0:1], 96
    v_lshrrev_b32 v9, 6, v0
    v_and_b32 v1, 63, v0
    v_readfirstlane_b32 s3, v9
    s_bfe_u32 s30, s2, 0x10003
    s_and_b32 s31, s2, 7
    s_lshr_b32 s63, s2, 4
    s_lshl_b32 s63, s63, 3
    s_or_b32 s31, s31, s63
    s_lshl_b32 s59, s30, 7
    s_add_u32 s59, s59, s31
    v_lshrrev_b32 v10, 4, v1
    v_and_b32 v11, 15, v1
    v_lshlrev_b32 v3, 4, v1
    s_cmp_ge_u32 s3, 4
    s_cbranch_scc1 L_helper
    s_setprio 1
    v_lshlrev_b32 v12, 2, v10
    v_xor_b32 v12, v12, v11
    v_lshlrev_b32 v12, 4, v12
    v_lshl_add_u32 v88, v10, 8, v12
    v_xor_b32 v89, 16, v88
    v_xor_b32 v90, 32, v88
    v_xor_b32 v91, 48, v88
    s_lshl_b32 s66, s3, 12
    s_mov_b32 s67, s66
    s_lshl_b32 s65, s59, 18
    s_mul_i32 s101, s3, 12288
    s_add_u32 s101, s101, 15616
    s_movk_i32 s58, 3584
    s_cmp_lt_u32 s31, 64
    s_cselect_b32 s58, 8192, s58
    s_lshl_b32 s63, s58, 4
    v_mul_u32_u24 v12, s63, v10
    v_lshl_add_u32 v12, v11, 3, v12
    s_lshl_b32 s62, s30, 2
    s_add_u32 s62, s62, s3
    s_lshl_b32 s62, s62, 6
    v_bfe_u32 v13, v11, 2, 1
    v_lshlrev_b32 v13, 10, v13
    v_lshl_add_u32 v13, v10, 5, v13
    s_lshl_b32 s63, s62, 1
    v_add_u32 v13, s63, v13
    s_mul_i32 s63, s62, s58
    s_sub_u32 s64, s31, 64
    s_cmp_lt_u32 s31, 64
    s_cselect_b32 s64, s31, s64
    s_sub_u32 s62, s31, 92
    s_cmp_ge_u32 s31, 92
    s_cselect_b32 s64, s62, s64
    s_lshl_b32 s64, s64, 7
    s_mul_i32 s42, s58, 511
    s_add_u32 s42, s42, 128
    s_mov_b32 s43, 0x20000
    s_mov_b32 s34, 0x40000
    s_mov_b32 s35, 0x20000
    s_waitcnt lgkmcnt(0)
    s_add_u32 s32, s6, s65
    s_addc_u32 s33, s7, 0
    s_cmp_ge_u32 s31, 120
    s_cbranch_scc1 L_noA1
    s_cmp_lt_u32 s31, 64
    s_cselect_b32 s40, s10, s16
    s_cselect_b32 s41, s11, s17
    s_cmp_ge_u32 s31, 92
    s_cselect_b32 s40, s18, s40
    s_cselect_b32 s41, s19, s41
    s_add_u32 s40, s40, s64
    s_addc_u32 s41, s41, 0
    global_load_dwordx4 v[64:67], v13, s[4:5]
    global_load_dwordx4 v[68:71], v13, s[4:5] offset:16
    buffer_load_dwordx2 v[32:33], v12, s[40:43], s63 offen nt
    s_add_u32 s63, s63, s58
    buffer_load_dwordx2 v[34:35], v12, s[40:43], s63 offen nt
    s_add_u32 s63, s63, s58
    buffer_load_dwordx2 v[36:37], v12, s[40:43], s63 offen nt
    s_add_u32 s63, s63, s58
    buffer_load_dwordx2 v[38:39], v12, s[40:43], s63 offen nt
    s_add_u32 s63, s63, s58
    buffer_load_dwordx2 v[40:41], v12, s[40:43], s63 offen nt
    s_add_u32 s63, s63, s58
    buffer_load_dwordx2 v[42:43], v12, s[40:43], s63 offen nt
    s_add_u32 s63, s63, s58
    buffer_load_dwordx2 v[44:45], v12, s[40:43], s63 offen nt
    s_add_u32 s63, s63, s58
    buffer_load_dwordx2 v[46:47], v12, s[40:43], s63 offen nt
    s_add_u32 s63, s63, s58
    buffer_load_dwordx2 v[48:49], v12, s[40:43], s63 offen nt
    s_add_u32 s63, s63, s58
    buffer_load_dwordx2 v[50:51], v12, s[40:43], s63 offen nt
    s_add_u32 s63, s63, s58
    buffer_load_dwordx2 v[52:53], v12, s[40:43], s63 offen nt
    s_add_u32 s63, s63, s58
    buffer_load_dwordx2 v[54:55], v12, s[40:43], s63 offen nt
    s_add_u32 s63, s63, s58
    s_waitcnt vmcnt(11)
    buffer_load_dwordx2 v[56:57], v12, s[40:43], s63 offen nt
    s_add_u32 s63, s63, s58
    s_waitcnt vmcnt(11)
    buffer_load_dwordx2 v[58:59], v12, s[40:43], s63 offen nt
    s_add_u32 s63, s63, s58
    s_waitcnt vmcnt(11)
    buffer_load_dwordx2 v[60:61], v12, s[40:43], s63 offen nt
    s_add_u32 s63, s63, s58
    s_waitcnt vmcnt(11)
    buffer_load_dwordx2 v[62:63], v12, s[40:43], s63 offen nt
L_noA1:
    s_waitcnt vmcnt(10)
    s_add_u32 s63, s101, 0
    s_mov_b32 m0, s63
    s_nop 0
    buffer_load_dwordx4 v88, s[32:35], s66 offen offset:0 nt lds
    s_load_dword s56, s[28:29], 0
    s_barrier
    s_add_u32 s36, s8, s65
    s_addc_u32 s37, s9, 0
    s_mov_b32 s38, 0x40000
    s_mov_b32 s39, 0x20000
    v_and_b32 v9, 1, v1
    v_cmp_eq_u32 vcc, 1, v9
    v_mov_b32 v12, 0x0c0c0100
    v_mov_b32 v9, 0x01000c0c
    v_mov_b32 v13, 0x0c0c0302
    v_mov_b32 v15, 0x03020c0c
    v_cndmask_b32 v12, v12, v9, vcc
    v_cndmask_b32 v13, v13, v15, vcc
    v_and_b32 v9, 2, v1
    v_cmp_eq_u32 vcc, 2, v9
    v_mov_b32 v15, 0x0c0c0c0c
    s_nop 0
    v_cndmask_b32 v4, v12, v15, vcc
    v_cndmask_b32 v5, v15, v12, vcc
    v_cndmask_b32 v6, v13, v15, vcc
    v_cndmask_b32 v7, v15, v13, vcc
    v_and_b32 v12, 3, v11
    v_lshlrev_b32 v12, 10, v12
    v_lshrrev_b32 v13, 2, v11
    v_lshl_add_u32 v12, v13, 8, v12
    v_xor_b32 v13, v10, v11
    v_lshl_add_u32 v12, v13, 4, v12
    v_add_u32 v92, s101, v12
    v_xor_b32 v93, 64, v92
    v_xor_b32 v94, 128, v92
    v_xor_b32 v95, 192, v92
    s_waitcnt vmcnt(9)
    buffer_load_dwordx4 v89, s[32:35], s66 offen offset:1024 nt lds
    s_cmp_ge_u32 s31, 120
    s_cbranch_scc1 L_skipA1
    s_waitcnt vmcnt(10)
    v_perm_b32 v96, v64, v64, v4
    v_perm_b32 v97, v64, v64, v5
    v_perm_b32 v98, v64, v64, v6
    v_perm_b32 v99, v64, v64, v7
    v_perm_b32 v100, v65, v65, v4
    v_perm_b32 v101, v65, v65, v5
    v_perm_b32 v102, v65, v65, v6
    v_perm_b32 v103, v65, v65, v7
    v_perm_b32 v104, v66, v66, v4
    v_perm_b32 v105, v66, v66, v5
    v_perm_b32 v106, v66, v66, v6
    v_perm_b32 v107, v66, v66, v7
    v_perm_b32 v108, v67, v67, v4
    v_perm_b32 v109, v67, v67, v5
    v_perm_b32 v110, v67, v67, v6
    v_perm_b32 v111, v67, v67, v7
    v_mfma_f32_16x16x16_bf16 v[72:75], v[96:97], v[32:33], 0
    v_mfma_f32_16x16x16_bf16 v[72:75], v[98:99], v[34:35], v[72:75]
    v_mfma_f32_16x16x16_bf16 v[72:75], v[100:101], v[36:37], v[72:75]
    v_mfma_f32_16x16x16_bf16 v[72:75], v[102:103], v[38:39], v[72:75]
    v_mfma_f32_16x16x16_bf16 v[72:75], v[104:105], v[40:41], v[72:75]
    v_mfma_f32_16x16x16_bf16 v[72:75], v[106:107], v[42:43], v[72:75]
    v_mfma_f32_16x16x16_bf16 v[72:75], v[108:109], v[44:45], v[72:75]
    v_mfma_f32_16x16x16_bf16 v[72:75], v[110:111], v[46:47], v[72:75]
L_skipA1:
    s_waitcnt vmcnt(8)
    buffer_load_dwordx4 v90, s[32:35], s66 offen offset:2048 nt lds
    s_waitcnt vmcnt(7)
    buffer_load_dwordx4 v91, s[32:35], s66 offen offset:3072 nt lds
    s_add_u32 s66, s66, 16384
    s_waitcnt vmcnt(6)
    s_add_u32 s63, s101, 4096
    s_mov_b32 m0, s63
    s_nop 0
    buffer_load_dwordx4 v88, s[32:35], s66 offen offset:0 nt lds
    s_waitcnt vmcnt(5)
    buffer_load_dwordx4 v89, s[32:35], s66 offen offset:1024 nt lds
    s_waitcnt vmcnt(5)
    buffer_load_dwordx4 v90, s[32:35], s66 offen offset:2048 nt lds
    s_cmp_ge_u32 s31, 120
    s_cbranch_scc1 L_skipA2
    s_waitcnt vmcnt(7)
    v_perm_b32 v96, v68, v68, v4
    v_perm_b32 v97, v68, v68, v5
    v_perm_b32 v98, v68, v68, v6
    v_perm_b32 v99, v68, v68, v7
    v_perm_b32 v100, v69, v69, v4
    v_perm_b32 v101, v69, v69, v5
    v_perm_b32 v102, v69, v69, v6
    v_perm_b32 v103, v69, v69, v7
    v_perm_b32 v104, v70, v70, v4
    v_perm_b32 v105, v70, v70, v5
    v_perm_b32 v106, v70, v70, v6
    v_perm_b32 v107, v70, v70, v7
    v_perm_b32 v108, v71, v71, v4
    v_perm_b32 v109, v71, v71, v5
    v_perm_b32 v110, v71, v71, v6
    v_perm_b32 v111, v71, v71, v7
    v_mfma_f32_16x16x16_bf16 v[72:75], v[96:97], v[48:49], v[72:75]
    v_mfma_f32_16x16x16_bf16 v[72:75], v[98:99], v[50:51], v[72:75]
    v_mfma_f32_16x16x16_bf16 v[72:75], v[100:101], v[52:53], v[72:75]
    v_mfma_f32_16x16x16_bf16 v[72:75], v[102:103], v[54:55], v[72:75]
    v_mfma_f32_16x16x16_bf16 v[72:75], v[104:105], v[56:57], v[72:75]
    v_mfma_f32_16x16x16_bf16 v[72:75], v[106:107], v[58:59], v[72:75]
    v_mfma_f32_16x16x16_bf16 v[72:75], v[108:109], v[60:61], v[72:75]
    v_mfma_f32_16x16x16_bf16 v[72:75], v[110:111], v[62:63], v[72:75]
    s_lshl_b32 s63, s3, 10
    v_add_u32 v9, s63, v3
    s_nop 6
    ds_write_b128 v9, v[72:75] offset:0
    v_mov_b32 v12, 0
    v_mov_b32 v13, 1
    s_mov_b64 exec, 1
    ds_add_u32 v12, v13 offset:5376
    s_mov_b64 exec, -1
L_skipA2:
    s_waitcnt vmcnt(5)
    buffer_load_dwordx4 v91, s[32:35], s66 offen offset:3072 nt lds
    s_add_u32 s66, s66, 16384
    s_waitcnt vmcnt(5)
    s_add_u32 s63, s101, 8192
    s_mov_b32 m0, s63
    s_nop 0
    buffer_load_dwordx4 v88, s[32:35], s66 offen offset:0 nt lds
    s_waitcnt vmcnt(5)
    buffer_load_dwordx4 v89, s[32:35], s66 offen offset:1024 nt lds
    s_waitcnt vmcnt(6)
    ds_read_b128 v[96:99], v92 offset:0
    ds_read_b128 v[100:103], v93 offset:0
    ds_read_b128 v[104:107], v94 offset:0
    ds_read_b128 v[108:111], v95 offset:0
    s_waitcnt vmcnt(5)
    buffer_load_dwordx4 v90, s[32:35], s66 offen offset:2048 nt lds
    s_waitcnt vmcnt(5)
    buffer_load_dwordx4 v91, s[32:35], s66 offen offset:3072 nt lds
    s_add_u32 s66, s66, 16384
    s_waitcnt vmcnt(5)
    s_add_u32 s63, s101, 0
    s_mov_b32 m0, s63
    s_waitcnt lgkmcnt(0)
    buffer_load_dwordx4 v88, s[32:35], s66 offen offset:0 nt lds
    s_waitcnt vmcnt(5)
    buffer_load_dwordx4 v89, s[32:35], s66 offen offset:1024 nt lds
    s_waitcnt vmcnt(6)
    ds_read_b128 v[112:115], v92 offset:4096
    ds_read_b128 v[116:119], v93 offset:4096
    ds_read_b128 v[120:123], v94 offset:4096
    ds_read_b128 v[124:127], v95 offset:4096
    s_waitcnt vmcnt(5)
    buffer_load_dwordx4 v90, s[32:35], s66 offen offset:2048 nt lds
    s_waitcnt vmcnt(5)
    buffer_load_dwordx4 v91, s[32:35], s66 offen offset:3072 nt lds
    s_add_u32 s66, s66, 16384
    s_waitcnt vmcnt(5)
    s_add_u32 s63, s101, 4096
    s_mov_b32 m0, s63
    s_waitcnt lgkmcnt(0)
    buffer_load_dwordx4 v88, s[32:35], s66 offen offset:0 nt lds
    s_waitcnt vmcnt(5)
    buffer_load_dwordx4 v89, s[32:35], s66 offen offset:1024 nt lds
    s_waitcnt vmcnt(6)
    ds_read_b128 v[128:131], v92 offset:8192
    ds_read_b128 v[132:135], v93 offset:8192
    ds_read_b128 v[136:139], v94 offset:8192
    ds_read_b128 v[140:143], v95 offset:8192
    s_waitcnt vmcnt(5)
    buffer_load_dwordx4 v90, s[32:35], s66 offen offset:2048 nt lds
    s_waitcnt vmcnt(5)
    buffer_load_dwordx4 v91, s[32:35], s66 offen offset:3072 nt lds
    s_add_u32 s66, s66, 16384
    s_waitcnt vmcnt(5)
    s_add_u32 s63, s101, 8192
    s_mov_b32 m0, s63
    s_waitcnt lgkmcnt(0)
    buffer_load_dwordx4 v88, s[32:35], s66 offen offset:0 nt lds
    s_waitcnt vmcnt(5)
    buffer_load_dwordx4 v89, s[32:35], s66 offen offset:1024 nt lds
    s_waitcnt vmcnt(6)
    ds_read_b128 v[144:147], v92 offset:0
    ds_read_b128 v[148:151], v93 offset:0
    ds_read_b128 v[152:155], v94 offset:0
    ds_read_b128 v[156:159], v95 offset:0
    s_waitcnt vmcnt(5)
    buffer_load_dwordx4 v90, s[32:35], s66 offen offset:2048 nt lds
    s_waitcnt vmcnt(5)
    buffer_load_dwordx4 v91, s[32:35], s66 offen offset:3072 nt lds
    s_add_u32 s66, s66, 16384
    s_waitcnt vmcnt(5)
    s_add_u32 s63, s101, 0
    s_mov_b32 m0, s63
    s_waitcnt lgkmcnt(0)
    buffer_load_dwordx4 v88, s[32:35], s66 offen offset:0 nt lds
    s_waitcnt vmcnt(5)
    buffer_load_dwordx4 v89, s[32:35], s66 offen offset:1024 nt lds
    s_waitcnt vmcnt(6)
    ds_read_b128 v[160:163], v92 offset:4096
    ds_read_b128 v[164:167], v93 offset:4096
    ds_read_b128 v[168:171], v94 offset:4096
    ds_read_b128 v[172:175], v95 offset:4096
    s_waitcnt vmcnt(5)
    buffer_load_dwordx4 v90, s[32:35], s66 offen offset:2048 nt lds
    s_waitcnt vmcnt(5)
    buffer_load_dwordx4 v91, s[32:35], s66 offen offset:3072 nt lds
    s_add_u32 s66, s66, 16384
    s_waitcnt vmcnt(5)
    s_add_u32 s63, s101, 4096
    s_mov_b32 m0, s63
    s_waitcnt lgkmcnt(0)
    buffer_load_dwordx4 v88, s[32:35], s66 offen offset:0 nt lds
    s_waitcnt vmcnt(5)
    buffer_load_dwordx4 v89, s[32:35], s66 offen offset:1024 nt lds
    s_waitcnt vmcnt(6)
    ds_read_b128 v[176:179], v92 offset:8192
    ds_read_b128 v[180:183], v93 offset:8192
    ds_read_b128 v[184:187], v94 offset:8192
    ds_read_b128 v[188:191], v95 offset:8192
    s_waitcnt vmcnt(5)
    buffer_load_dwordx4 v90, s[32:35], s66 offen offset:2048 nt lds
    s_cmp_lg_u32 s3, 0
    s_cbranch_scc1 L_pg3
    v_mov_b32 v12, 0
    v_mov_b32 v13, 30
    ds_write_b32 v12, v13 offset:5388
L_pg3:
    s_waitcnt vmcnt(5)
    buffer_load_dwordx4 v91, s[32:35], s66 offen offset:3072 nt lds
    s_add_u32 s66, s66, 16384
    s_waitcnt vmcnt(5)
    s_add_u32 s63, s101, 8192
    s_mov_b32 m0, s63
    s_waitcnt lgkmcnt(0)
    buffer_load_dwordx4 v88, s[32:35], s66 offen offset:0 nt lds
    s_waitcnt vmcnt(5)
    buffer_load_dwordx4 v89, s[32:35], s66 offen offset:1024 nt lds
    s_waitcnt vmcnt(6)
    ds_read_b128 v[192:195], v92 offset:0
    ds_read_b128 v[196:199], v93 offset:0
    ds_read_b128 v[200:203], v94 offset:0
    ds_read_b128 v[204:207], v95 offset:0
    s_waitcnt vmcnt(5)
    buffer_load_dwordx4 v90, s[32:35], s66 offen offset:2048 nt lds
    s_waitcnt vmcnt(5)
    buffer_load_dwordx4 v91, s[32:35], s66 offen offset:3072 nt lds
    s_add_u32 s66, s66, 16384
    s_waitcnt vmcnt(5)
    s_add_u32 s63, s101, 0
    s_mov_b32 m0, s63
    s_waitcnt lgkmcnt(0)
    buffer_load_dwordx4 v88, s[32:35], s66 offen offset:0 nt lds
    s_waitcnt vmcnt(5)
    buffer_load_dwordx4 v89, s[32:35], s66 offen offset:1024 nt lds
    s_waitcnt vmcnt(6)
    ds_read_b128 v[208:211], v92 offset:4096
    ds_read_b128 v[212:215], v93 offset:4096
    ds_read_b128 v[216:219], v94 offset:4096
    ds_read_b128 v[220:223], v95 offset:4096
    s_waitcnt vmcnt(5)
    buffer_load_dwordx4 v90, s[32:35], s66 offen offset:2048 nt lds
    s_waitcnt vmcnt(5)
    buffer_load_dwordx4 v91, s[32:35], s66 offen offset:3072 nt lds
    s_add_u32 s66, s66, 16384
    s_waitcnt vmcnt(5)
    s_add_u32 s63, s101, 4096
    s_mov_b32 m0, s63
    s_waitcnt lgkmcnt(0)
    buffer_load_dwordx4 v88, s[32:35], s66 offen offset:0 nt lds
    s_waitcnt vmcnt(5)
    buffer_load_dwordx4 v89, s[32:35], s66 offen offset:1024 nt lds
    s_waitcnt vmcnt(6)
    ds_read_b128 v[224:227], v92 offset:8192
    ds_read_b128 v[228:231], v93 offset:8192
    ds_read_b128 v[232:235], v94 offset:8192
    ds_read_b128 v[236:239], v95 offset:8192
    s_waitcnt vmcnt(5)
    buffer_load_dwordx4 v90, s[32:35], s66 offen offset:2048 nt lds
    s_waitcnt vmcnt(5)
    buffer_load_dwordx4 v91, s[32:35], s66 offen offset:3072 nt lds
    s_add_u32 s66, s66, 16384
    v_lshrrev_b32 v9, 2, v11
    v_lshlrev_b32 v9, 8, v9
    v_lshl_add_u32 v9, v10, 4, v9
    v_mov_b32 v12, 0
    s_mov_b32 s62, 0
    s_branch L_lw4_n
L_lw4:
L_lw4_n:
    ds_read_b32 v13, v12 offset:5384
    s_add_u32 s62, s62, 1
    s_cmp_gt_u32 s62, 16000000
    s_cbranch_scc1 L_bail
    s_waitcnt lgkmcnt(0)
    v_readfirstlane_b32 s63, v13
    s_cmp_lt_u32 s63, 4
    s_cbranch_scc1 L_lw4
    ds_read_b128 v[16:19], v9 offset:4096
    ds_read_b128 v[20:23], v9 offset:4160
    ds_read_b128 v[24:27], v9 offset:4224
    ds_read_b128 v[28:31], v9 offset:4288
    s_waitcnt vmcnt(5)
    s_add_u32 s63, s101, 8192
    s_mov_b32 m0, s63
    s_waitcnt lgkmcnt(0)
    buffer_load_dwordx4 v88, s[32:35], s66 offen offset:0 nt lds
    s_waitcnt lgkmcnt(0)
    v_mfma_f32_16x16x32_bf16 v[32:35], v[96:99], v[16:19], 0
    v_mfma_f32_16x16x32_bf16 v[32:35], v[100:103], v[20:23], v[32:35]
    v_mfma_f32_16x16x32_bf16 v[32:35], v[104:107], v[24:27], v[32:35]
    v_mfma_f32_16x16x32_bf16 v[32:35], v[108:111], v[28:31], v[32:35]
    v_mfma_f32_16x16x32_bf16 v[36:39], v[112:115], v[16:19], 0
    v_mfma_f32_16x16x32_bf16 v[36:39], v[116:119], v[20:23], v[36:39]
    v_mfma_f32_16x16x32_bf16 v[36:39], v[120:123], v[24:27], v[36:39]
    v_mfma_f32_16x16x32_bf16 v[36:39], v[124:127], v[28:31], v[36:39]
    s_waitcnt vmcnt(5)
    buffer_load_dwordx4 v89, s[32:35], s66 offen offset:1024 nt lds
    s_waitcnt vmcnt(6)
    ds_read_b128 v[240:243], v92 offset:0
    ds_read_b128 v[244:247], v93 offset:0
    ds_read_b128 v[248:251], v94 offset:0
    ds_read_b128 v[252:255], v95 offset:0
    s_waitcnt lgkmcnt(0)
    v_mfma_f32_16x16x32_bf16 v[40:43], v[128:131], v[16:19], 0
    v_mfma_f32_16x16x32_bf16 v[40:43], v[132:135], v[20:23], v[40:43]
    v_mfma_f32_16x16x32_bf16 v[40:43], v[136:139], v[24:27], v[40:43]
    v_mfma_f32_16x16x32_bf16 v[40:43], v[140:143], v[28:31], v[40:43]
    v_mfma_f32_16x16x32_bf16 v[44:47], v[144:147], v[16:19], 0
    v_mfma_f32_16x16x32_bf16 v[44:47], v[148:151], v[20:23], v[44:47]
    v_mfma_f32_16x16x32_bf16 v[44:47], v[152:155], v[24:27], v[44:47]
    v_mfma_f32_16x16x32_bf16 v[44:47], v[156:159], v[28:31], v[44:47]
    s_waitcnt vmcnt(5)
    buffer_load_dwordx4 v90, s[32:35], s66 offen offset:2048 nt lds
    s_waitcnt lgkmcnt(0)
    v_mfma_f32_16x16x32_bf16 v[48:51], v[160:163], v[16:19], 0
    v_mfma_f32_16x16x32_bf16 v[48:51], v[164:167], v[20:23], v[48:51]
    v_mfma_f32_16x16x32_bf16 v[48:51], v[168:171], v[24:27], v[48:51]
    v_mfma_f32_16x16x32_bf16 v[48:51], v[172:175], v[28:31], v[48:51]
    v_mfma_f32_16x16x32_bf16 v[52:55], v[176:179], v[16:19], 0
    v_mfma_f32_16x16x32_bf16 v[52:55], v[180:183], v[20:23], v[52:55]
    v_mfma_f32_16x16x32_bf16 v[52:55], v[184:187], v[24:27], v[52:55]
    v_mfma_f32_16x16x32_bf16 v[52:55], v[188:191], v[28:31], v[52:55]
    s_waitcnt vmcnt(5)
    buffer_load_dwordx4 v91, s[32:35], s66 offen offset:3072 nt lds
    s_add_u32 s66, s66, 16384
    s_waitcnt lgkmcnt(0)
    v_mfma_f32_16x16x32_bf16 v[56:59], v[192:195], v[16:19], 0
    v_mfma_f32_16x16x32_bf16 v[56:59], v[196:199], v[20:23], v[56:59]
    v_mfma_f32_16x16x32_bf16 v[56:59], v[200:203], v[24:27], v[56:59]
    v_mfma_f32_16x16x32_bf16 v[56:59], v[204:207], v[28:31], v[56:59]
    v_mfma_f32_16x16x32_bf16 v[60:63], v[208:211], v[16:19], 0
    v_mfma_f32_16x16x32_bf16 v[60:63], v[212:215], v[20:23], v[60:63]
    v_mfma_f32_16x16x32_bf16 v[60:63], v[216:219], v[24:27], v[60:63]
    v_mfma_f32_16x16x32_bf16 v[60:63], v[220:223], v[28:31], v[60:63]
    s_waitcnt vmcnt(5)
    s_add_u32 s63, s101, 0
    s_mov_b32 m0, s63
    s_waitcnt lgkmcnt(0)
    buffer_load_dwordx4 v88, s[32:35], s66 offen offset:0 nt lds
    s_waitcnt lgkmcnt(0)
    v_mfma_f32_16x16x32_bf16 v[64:67], v[224:227], v[16:19], 0
    v_mfma_f32_16x16x32_bf16 v[64:67], v[228:231], v[20:23], v[64:67]
    v_mfma_f32_16x16x32_bf16 v[64:67], v[232:235], v[24:27], v[64:67]
    v_mfma_f32_16x16x32_bf16 v[64:67], v[236:239], v[28:31], v[64:67]
    v_mfma_f32_16x16x32_bf16 v[68:71], v[240:243], v[16:19], 0
    v_mfma_f32_16x16x32_bf16 v[68:71], v[244:247], v[20:23], v[68:71]
    v_mfma_f32_16x16x32_bf16 v[68:71], v[248:251], v[24:27], v[68:71]
    v_mfma_f32_16x16x32_bf16 v[68:71], v[252:255], v[28:31], v[68:71]
    s_waitcnt vmcnt(5)
    buffer_load_dwordx4 v89, s[32:35], s66 offen offset:1024 nt lds
    s_waitcnt vmcnt(6)
    ds_read_b128 v[96:99], v92 offset:4096
    ds_read_b128 v[100:103], v93 offset:4096
    ds_read_b128 v[104:107], v94 offset:4096
    ds_read_b128 v[108:111], v95 offset:4096
    s_waitcnt vmcnt(5)
    buffer_load_dwordx4 v90, s[32:35], s66 offen offset:2048 nt lds
    s_cmp_lg_u32 s3, 0
    s_cbranch_scc1 L_pg5
    v_mov_b32 v12, 0
    v_mov_b32 v13, 50
    ds_write_b32 v12, v13 offset:5388
L_pg5:
    s_waitcnt lgkmcnt(0)
    v_mfma_f32_16x16x32_bf16 v[72:75], v[96:99], v[16:19], 0
    v_mfma_f32_16x16x32_bf16 v[72:75], v[100:103], v[20:23], v[72:75]
    v_mfma_f32_16x16x32_bf16 v[72:75], v[104:107], v[24:27], v[72:75]
    v_mfma_f32_16x16x32_bf16 v[72:75], v[108:111], v[28:31], v[72:75]
    s_waitcnt vmcnt(5)
    buffer_load_dwordx4 v91, s[32:35], s66 offen offset:3072 nt lds
    s_add_u32 s66, s66, 16384
    s_waitcnt vmcnt(5)
    s_add_u32 s63, s101, 4096
    s_mov_b32 m0, s63
    s_waitcnt lgkmcnt(0)
    buffer_load_dwordx4 v88, s[32:35], s66 offen offset:0 nt lds
    s_waitcnt vmcnt(5)
    buffer_load_dwordx4 v89, s[32:35], s66 offen offset:1024 nt lds
    s_waitcnt vmcnt(6)
    ds_read_b128 v[112:115], v92 offset:8192
    ds_read_b128 v[116:119], v93 offset:8192
    ds_read_b128 v[120:123], v94 offset:8192
    ds_read_b128 v[124:127], v95 offset:8192
    s_waitcnt vmcnt(5)
    buffer_load_dwordx4 v90, s[32:35], s66 offen offset:2048 nt lds
    s_waitcnt lgkmcnt(0)
    v_mfma_f32_16x16x32_bf16 v[76:79], v[112:115], v[16:19], 0
    v_mfma_f32_16x16x32_bf16 v[76:79], v[116:119], v[20:23], v[76:79]
    v_mfma_f32_16x16x32_bf16 v[76:79], v[120:123], v[24:27], v[76:79]
    v_mfma_f32_16x16x32_bf16 v[76:79], v[124:127], v[28:31], v[76:79]
    s_waitcnt vmcnt(5)
    buffer_load_dwordx4 v91, s[32:35], s66 offen offset:3072 nt lds
    s_add_u32 s66, s66, 16384
    s_waitcnt vmcnt(5)
    s_add_u32 s63, s101, 8192
    s_mov_b32 m0, s63
    s_waitcnt lgkmcnt(0)
    buffer_load_dwordx4 v88, s[32:35], s66 offen offset:0 nt lds
    s_waitcnt vmcnt(5)
    buffer_load_dwordx4 v89, s[32:35], s66 offen offset:1024 nt lds
    s_waitcnt vmcnt(6)
    ds_read_b128 v[128:131], v92 offset:0
    ds_read_b128 v[132:135], v93 offset:0
    ds_read_b128 v[136:139], v94 offset:0
    ds_read_b128 v[140:143], v95 offset:0
    s_waitcnt vmcnt(5)
    buffer_load_dwordx4 v90, s[32:35], s66 offen offset:2048 nt lds
    s_waitcnt lgkmcnt(0)
    v_mfma_f32_16x16x32_bf16 v[80:83], v[128:131], v[16:19], 0
    v_mfma_f32_16x16x32_bf16 v[80:83], v[132:135], v[20:23], v[80:83]
    v_mfma_f32_16x16x32_bf16 v[80:83], v[136:139], v[24:27], v[80:83]
    v_mfma_f32_16x16x32_bf16 v[80:83], v[140:143], v[28:31], v[80:83]
    s_waitcnt vmcnt(5)
    buffer_load_dwordx4 v91, s[32:35], s66 offen offset:3072 nt lds
    s_add_u32 s66, s66, 16384
    s_waitcnt vmcnt(5)
    s_add_u32 s63, s101, 0
    s_mov_b32 m0, s63
    s_waitcnt lgkmcnt(0)
    buffer_load_dwordx4 v88, s[32:35], s66 offen offset:0 nt lds
    s_waitcnt vmcnt(5)
    buffer_load_dwordx4 v89, s[32:35], s66 offen offset:1024 nt lds
    s_waitcnt vmcnt(6)
    ds_read_b128 v[144:147], v92 offset:4096
    ds_read_b128 v[148:151], v93 offset:4096
    ds_read_b128 v[152:155], v94 offset:4096
    ds_read_b128 v[156:159], v95 offset:4096
    s_waitcnt vmcnt(5)
    buffer_load_dwordx4 v90, s[32:35], s66 offen offset:2048 nt lds
    s_waitcnt lgkmcnt(0)
    v_mfma_f32_16x16x32_bf16 v[84:87], v[144:147], v[16:19], 0
    v_mfma_f32_16x16x32_bf16 v[84:87], v[148:151], v[20:23], v[84:87]
    v_mfma_f32_16x16x32_bf16 v[84:87], v[152:155], v[24:27], v[84:87]
    v_mfma_f32_16x16x32_bf16 v[84:87], v[156:159], v[28:31], v[84:87]
    s_waitcnt vmcnt(5)
    buffer_load_dwordx4 v91, s[32:35], s66 offen offset:3072 nt lds
    s_waitcnt vmcnt(5)
    buffer_load_dwordx4 v[192:195], v3, s[36:39], s67 offen offset:0 nt
    s_waitcnt vmcnt(5)
    buffer_load_dwordx4 v[196:199], v3, s[36:39], s67 offen offset:1024 nt
    s_waitcnt vmcnt(6)
    ds_read_b128 v[160:163], v92 offset:8192
    ds_read_b128 v[164:167], v93 offset:8192
    ds_read_b128 v[168:171], v94 offset:8192
    ds_read_b128 v[172:175], v95 offset:8192
    s_waitcnt vmcnt(5)
    buffer_load_dwordx4 v[200:203], v3, s[36:39], s67 offen offset:2048 nt
    s_waitcnt lgkmcnt(0)
    v_mfma_f32_16x16x32_bf16 v[88:91], v[160:163], v[16:19], 0
    v_mfma_f32_16x16x32_bf16 v[88:91], v[164:167], v[20:23], v[88:91]
    v_mfma_f32_16x16x32_bf16 v[88:91], v[168:171], v[24:27], v[88:91]
    v_mfma_f32_16x16x32_bf16 v[88:91], v[172:175], v[28:31], v[88:91]
    s_waitcnt vmcnt(5)
    buffer_load_dwordx4 v[204:207], v3, s[36:39], s67 offen offset:3072 nt
    s_add_u32 s67, s67, 16384
    s_waitcnt vmcnt(5)
    buffer_load_dwordx4 v[208:211], v3, s[36:39], s67 offen offset:0 nt
    s_waitcnt vmcnt(5)
    buffer_load_dwordx4 v[212:215], v3, s[36:39], s67 offen offset:1024 nt
    s_waitcnt vmcnt(6)
    ds_read_b128 v[176:179], v92 offset:0
    ds_read_b128 v[180:183], v93 offset:0
    ds_read_b128 v[184:187], v94 offset:0
    ds_read_b128 v[188:191], v95 offset:0
    s_waitcnt vmcnt(5)
    buffer_load_dwordx4 v[216:219], v3, s[36:39], s67 offen offset:2048 nt
    s_waitcnt lgkmcnt(0)
    v_mfma_f32_16x16x32_bf16 v[92:95], v[176:179], v[16:19], 0
    v_mfma_f32_16x16x32_bf16 v[92:95], v[180:183], v[20:23], v[92:95]
    v_mfma_f32_16x16x32_bf16 v[92:95], v[184:187], v[24:27], v[92:95]
    v_mfma_f32_16x16x32_bf16 v[92:95], v[188:191], v[28:31], v[92:95]
    s_waitcnt vmcnt(5)
    buffer_load_dwordx4 v[220:223], v3, s[36:39], s67 offen offset:3072 nt
    s_add_u32 s67, s67, 16384
    v_max3_f32 v9, v32, v33, v34
    v_max3_f32 v14, v35, v36, v37
    v_max3_f32 v9, v9, v38, v39
    v_max3_f32 v14, v14, v40, v41
    v_max3_f32 v9, v9, v42, v43
    v_max3_f32 v14, v14, v44, v45
    v_max3_f32 v9, v9, v46, v47
    v_max3_f32 v14, v14, v48, v49
    v_max3_f32 v9, v9, v50, v51
    v_max3_f32 v14, v14, v52, v53
    v_max3_f32 v9, v9, v54, v55
    v_max3_f32 v14, v14, v56, v57
    v_max3_f32 v9, v9, v58, v59
    v_max3_f32 v14, v14, v60, v61
    v_max3_f32 v9, v9, v62, v63
    v_max3_f32 v14, v14, v64, v65
    v_max3_f32 v9, v9, v66, v67
    v_max3_f32 v14, v14, v68, v69
    v_max3_f32 v9, v9, v70, v71
    v_max3_f32 v14, v14, v72, v73
    v_max3_f32 v9, v9, v74, v75
    v_max3_f32 v14, v14, v76, v77
    v_max3_f32 v9, v9, v78, v79
    v_max3_f32 v14, v14, v80, v81
    v_max3_f32 v9, v9, v82, v83
    v_max3_f32 v14, v14, v84, v85
    v_max3_f32 v9, v9, v86, v87
    v_max3_f32 v14, v14, v88, v89
    v_max3_f32 v9, v9, v90, v91
    v_max3_f32 v14, v14, v92, v93
    v_max3_f32 v9, v9, v94, v95
    v_max_f32 v9, v9, v14
    s_mov_b32 s65, 0x3e0293ee
    v_mov_b32 v12, v9
    s_nop 1
    v_permlane16_swap_b32 v12, v9
    v_max_f32 v9, v12, v9
    v_mov_b32 v12, v9
    s_nop 1
    v_permlane32_swap_b32 v12, v9
    v_max_f32 v9, v12, v9
    v_mul_f32 v9, s65, v9
    s_waitcnt vmcnt(5)
    buffer_load_dwordx4 v[224:227], v3, s[36:39], s67 offen offset:0 nt
    v_fma_f32 v32, v32, s65, -v9
    v_fma_f32 v33, v33, s65, -v9
    v_fma_f32 v34, v34, s65, -v9
    v_fma_f32 v35, v35, s65, -v9
    v_fma_f32 v36, v36, s65, -v9
    v_fma_f32 v37, v37, s65, -v9
    v_fma_f32 v38, v38, s65, -v9
    v_fma_f32 v39, v39, s65, -v9
    v_fma_f32 v40, v40, s65, -v9
    v_fma_f32 v41, v41, s65, -v9
    v_fma_f32 v42, v42, s65, -v9
    v_fma_f32 v43, v43, s65, -v9
    v_fma_f32 v44, v44, s65, -v9
    v_fma_f32 v45, v45, s65, -v9
    v_fma_f32 v46, v46, s65, -v9
    v_fma_f32 v47, v47, s65, -v9
    v_exp_f32 v32, v32
    v_exp_f32 v33, v33
    v_exp_f32 v34, v34
    v_exp_f32 v35, v35
    v_exp_f32 v36, v36
    v_exp_f32 v37, v37
    v_exp_f32 v38, v38
    v_exp_f32 v39, v39
    v_exp_f32 v40, v40
    v_exp_f32 v41, v41
    v_exp_f32 v42, v42
    v_exp_f32 v43, v43
    v_exp_f32 v44, v44
    v_exp_f32 v45, v45
    v_exp_f32 v46, v46
    v_exp_f32 v47, v47
    s_waitcnt vmcnt(5)
    buffer_load_dwordx4 v[228:231], v3, s[36:39], s67 offen offset:1024 nt
    v_fma_f32 v48, v48, s65, -v9
    v_fma_f32 v49, v49, s65, -v9
    v_fma_f32 v50, v50, s65, -v9
    v_fma_f32 v51, v51, s65, -v9
    v_fma_f32 v52, v52, s65, -v9
    v_fma_f32 v53, v53, s65, -v9
    v_fma_f32 v54, v54, s65, -v9
    v_fma_f32 v55, v55, s65, -v9
    v_fma_f32 v56, v56, s65, -v9
    v_fma_f32 v57, v57, s65, -v9
    v_fma_f32 v58, v58, s65, -v9
    v_fma_f32 v59, v59, s65, -v9
    v_fma_f32 v60, v60, s65, -v9
    v_fma_f32 v61, v61, s65, -v9
    v_fma_f32 v62, v62, s65, -v9
    v_fma_f32 v63, v63, s65, -v9
    v_exp_f32 v48, v48
    v_exp_f32 v49, v49
    v_exp_f32 v50, v50
    v_exp_f32 v51, v51
    v_exp_f32 v52, v52
    v_exp_f32 v53, v53
    v_exp_f32 v54, v54
    v_exp_f32 v55, v55
    v_exp_f32 v56, v56
    v_exp_f32 v57, v57
    v_exp_f32 v58, v58
    v_exp_f32 v59, v59
    v_exp_f32 v60, v60
    v_exp_f32 v61, v61
    v_exp_f32 v62, v62
    v_exp_f32 v63, v63
    s_waitcnt vmcnt(5)
    buffer_load_dwordx4 v[232:235], v3, s[36:39], s67 offen offset:2048 nt
    v_fma_f32 v64, v64, s65, -v9
    v_fma_f32 v65, v65, s65, -v9
    v_fma_f32 v66, v66, s65, -v9
    v_fma_f32 v67, v67, s65, -v9
    v_fma_f32 v68, v68, s65, -v9
    v_fma_f32 v69, v69, s65, -v9
    v_fma_f32 v70, v70, s65, -v9
    v_fma_f32 v71, v71, s65, -v9
    v_fma_f32 v72, v72, s65, -v9
    v_fma_f32 v73, v73, s65, -v9
    v_fma_f32 v74, v74, s65, -v9
    v_fma_f32 v75, v75, s65, -v9
    v_fma_f32 v76, v76, s65, -v9
    v_fma_f32 v77, v77, s65, -v9
    v_fma_f32 v78, v78, s65, -v9
    v_fma_f32 v79, v79, s65, -v9
    v_exp_f32 v64, v64
    v_exp_f32 v65, v65
    v_exp_f32 v66, v66
    v_exp_f32 v67, v67
    v_exp_f32 v68, v68
    v_exp_f32 v69, v69
    v_exp_f32 v70, v70
    v_exp_f32 v71, v71
    v_exp_f32 v72, v72
    v_exp_f32 v73, v73
    v_exp_f32 v74, v74
    v_exp_f32 v75, v75
    v_exp_f32 v76, v76
    v_exp_f32 v77, v77
    v_exp_f32 v78, v78
    v_exp_f32 v79, v79
    s_waitcnt vmcnt(5)
    buffer_load_dwordx4 v[236:239], v3, s[36:39], s67 offen offset:3072 nt
    s_add_u32 s67, s67, 16384
    v_fma_f32 v80, v80, s65, -v9
    v_fma_f32 v81, v81, s65, -v9
    v_fma_f32 v82, v82, s65, -v9
    v_fma_f32 v83, v83, s65, -v9
    v_fma_f32 v84, v84, s65, -v9
    v_fma_f32 v85, v85, s65, -v9
    v_fma_f32 v86, v86, s65, -v9
    v_fma_f32 v87, v87, s65, -v9
    v_fma_f32 v88, v88, s65, -v9
    v_fma_f32 v89, v89, s65, -v9
    v_fma_f32 v90, v90, s65, -v9
    v_fma_f32 v91, v91, s65, -v9
    v_fma_f32 v92, v92, s65, -v9
    v_fma_f32 v93, v93, s65, -v9
    v_fma_f32 v94, v94, s65, -v9
    v_fma_f32 v95, v95, s65, -v9
    v_exp_f32 v80, v80
    v_exp_f32 v81, v81
    v_exp_f32 v82, v82
    v_exp_f32 v83, v83
    v_exp_f32 v84, v84
    v_exp_f32 v85, v85
    v_exp_f32 v86, v86
    v_exp_f32 v87, v87
    v_exp_f32 v88, v88
    v_exp_f32 v89, v89
    v_exp_f32 v90, v90
    v_exp_f32 v91, v91
    v_exp_f32 v92, v92
    v_exp_f32 v93, v93
    v_exp_f32 v94, v94
    v_exp_f32 v95, v95
    s_waitcnt vmcnt(5)
    buffer_load_dwordx4 v[240:243], v3, s[36:39], s67 offen offset:0 nt
    v_mov_b32 v14, v32
    v_mov_b32 v15, v33
    v_pk_add_f32 v[14:15], v[14:15], v[34:35]
    v_pk_add_f32 v[14:15], v[14:15], v[36:37]
    v_pk_add_f32 v[14:15], v[14:15], v[38:39]
    v_pk_add_f32 v[14:15], v[14:15], v[40:41]
    v_pk_add_f32 v[14:15], v[14:15], v[42:43]
    v_pk_add_f32 v[14:15], v[14:15], v[44:45]
    v_pk_add_f32 v[14:15], v[14:15], v[46:47]
    v_pk_add_f32 v[14:15], v[14:15], v[48:49]
    v_pk_add_f32 v[14:15], v[14:15], v[50:51]
    v_pk_add_f32 v[14:15], v[14:15], v[52:53]
    v_pk_add_f32 v[14:15], v[14:15], v[54:55]
    v_pk_add_f32 v[14:15], v[14:15], v[56:57]
    v_pk_add_f32 v[14:15], v[14:15], v[58:59]
    v_pk_add_f32 v[14:15], v[14:15], v[60:61]
    v_pk_add_f32 v[14:15], v[14:15], v[62:63]
    v_cvt_pk_bf16_f32 v32, v32, v33
    v_cvt_pk_bf16_f32 v33, v34, v35
    v_cvt_pk_bf16_f32 v34, v36, v37
    v_cvt_pk_bf16_f32 v35, v38, v39
    v_cvt_pk_bf16_f32 v36, v40, v41
    v_cvt_pk_bf16_f32 v37, v42, v43
    v_cvt_pk_bf16_f32 v38, v44, v45
    v_cvt_pk_bf16_f32 v39, v46, v47
    v_cvt_pk_bf16_f32 v40, v48, v49
    v_cvt_pk_bf16_f32 v41, v50, v51
    v_cvt_pk_bf16_f32 v42, v52, v53
    v_cvt_pk_bf16_f32 v43, v54, v55
    v_cvt_pk_bf16_f32 v44, v56, v57
    v_cvt_pk_bf16_f32 v45, v58, v59
    v_cvt_pk_bf16_f32 v46, v60, v61
    v_cvt_pk_bf16_f32 v47, v62, v63
    s_waitcnt vmcnt(5)
    buffer_load_dwordx4 v[244:247], v3, s[36:39], s67 offen offset:1024 nt
    v_pk_add_f32 v[14:15], v[14:15], v[64:65]
    v_pk_add_f32 v[14:15], v[14:15], v[66:67]
    v_pk_add_f32 v[14:15], v[14:15], v[68:69]
    v_pk_add_f32 v[14:15], v[14:15], v[70:71]
    v_pk_add_f32 v[14:15], v[14:15], v[72:73]
    v_pk_add_f32 v[14:15], v[14:15], v[74:75]
    v_pk_add_f32 v[14:15], v[14:15], v[76:77]
    v_pk_add_f32 v[14:15], v[14:15], v[78:79]
    v_pk_add_f32 v[14:15], v[14:15], v[80:81]
    v_pk_add_f32 v[14:15], v[14:15], v[82:83]
    v_pk_add_f32 v[14:15], v[14:15], v[84:85]
    v_pk_add_f32 v[14:15], v[14:15], v[86:87]
    v_pk_add_f32 v[14:15], v[14:15], v[88:89]
    v_pk_add_f32 v[14:15], v[14:15], v[90:91]
    v_pk_add_f32 v[14:15], v[14:15], v[92:93]
    v_pk_add_f32 v[14:15], v[14:15], v[94:95]
    v_cvt_pk_bf16_f32 v48, v64, v65
    v_cvt_pk_bf16_f32 v49, v66, v67
    v_cvt_pk_bf16_f32 v50, v68, v69
    v_cvt_pk_bf16_f32 v51, v70, v71
    v_cvt_pk_bf16_f32 v52, v72, v73
    v_cvt_pk_bf16_f32 v53, v74, v75
    v_cvt_pk_bf16_f32 v54, v76, v77
    v_cvt_pk_bf16_f32 v55, v78, v79
    v_cvt_pk_bf16_f32 v56, v80, v81
    v_cvt_pk_bf16_f32 v57, v82, v83
    v_cvt_pk_bf16_f32 v58, v84, v85
    v_cvt_pk_bf16_f32 v59, v86, v87
    v_cvt_pk_bf16_f32 v60, v88, v89
    v_cvt_pk_bf16_f32 v61, v90, v91
    v_cvt_pk_bf16_f32 v62, v92, v93
    v_cvt_pk_bf16_f32 v63, v94, v95
    v_add_f32 v15, v15, v14
    v_mov_b32 v14, v15
    s_nop 1
    v_permlane16_swap_b32 v14, v15
    v_add_f32 v15, v14, v15
    v_mov_b32 v14, v15
    s_nop 1
    v_permlane32_swap_b32 v14, v15
    v_add_f32 v15, v14, v15
    v_lshrrev_b32 v14, 2, v11
    v_lshlrev_b32 v14, 4, v14
    s_lshl_b32 s63, s3, 2
    v_add_u32 v14, s63, v14
    ds_write_b32 v14, v9 offset:5120
    ds_write_b32 v14, v15 offset:5184
    v_mov_b32 v12, 0
    v_mov_b32 v13, 1
    s_mov_b64 exec, 1
    ds_add_u32 v12, v13 offset:5380
    s_mov_b64 exec, -1
    s_waitcnt vmcnt(5)
    buffer_load_dwordx4 v[248:251], v3, s[36:39], s67 offen offset:2048 nt
    s_waitcnt vmcnt(5)
    buffer_load_dwordx4 v[252:255], v3, s[36:39], s67 offen offset:3072 nt
    s_add_u32 s67, s67, 16384
    v_perm_b32 v24, v32, v32, v4
    v_perm_b32 v25, v32, v32, v5
    v_perm_b32 v26, v32, v32, v6
    v_perm_b32 v27, v32, v32, v7
    v_perm_b32 v28, v33, v33, v4
    v_perm_b32 v29, v33, v33, v5
    v_perm_b32 v30, v33, v33, v6
    v_perm_b32 v31, v33, v33, v7
    s_waitcnt vmcnt(12)
    v_mfma_f32_16x16x16_bf16 v[16:19], v[24:25], v[192:193], 0
    v_mfma_f32_16x16x16_bf16 v[20:23], v[24:25], v[194:195], 0
    v_mfma_f32_16x16x16_bf16 v[16:19], v[26:27], v[196:197], v[16:19]
    v_mfma_f32_16x16x16_bf16 v[20:23], v[26:27], v[198:199], v[20:23]
    v_mfma_f32_16x16x16_bf16 v[16:19], v[28:29], v[200:201], v[16:19]
    v_mfma_f32_16x16x16_bf16 v[20:23], v[28:29], v[202:203], v[20:23]
    v_mfma_f32_16x16x16_bf16 v[16:19], v[30:31], v[204:205], v[16:19]
    v_mfma_f32_16x16x16_bf16 v[20:23], v[30:31], v[206:207], v[20:23]
    s_waitcnt vmcnt(5)
    buffer_load_dwordx4 v[96:99], v3, s[36:39], s67 offen offset:0 nt
    s_waitcnt vmcnt(5)
    buffer_load_dwordx4 v[100:103], v3, s[36:39], s67 offen offset:1024 nt
    s_waitcnt vmcnt(5)
    buffer_load_dwordx4 v[104:107], v3, s[36:39], s67 offen offset:2048 nt
    s_waitcnt vmcnt(5)
    buffer_load_dwordx4 v[108:111], v3, s[36:39], s67 offen offset:3072 nt
    s_add_u32 s67, s67, 16384
    v_perm_b32 v24, v34, v34, v4
    v_perm_b32 v25, v34, v34, v5
    v_perm_b32 v26, v34, v34, v6
    v_perm_b32 v27, v34, v34, v7
    v_perm_b32 v28, v35, v35, v4
    v_perm_b32 v29, v35, v35, v5
    v_perm_b32 v30, v35, v35, v6
    v_perm_b32 v31, v35, v35, v7
    s_waitcnt vmcnt(12)
    v_mfma_f32_16x16x16_bf16 v[16:19], v[24:25], v[208:209], v[16:19]
    v_mfma_f32_16x16x16_bf16 v[20:23], v[24:25], v[210:211], v[20:23]
    v_mfma_f32_16x16x16_bf16 v[16:19], v[26:27], v[212:213], v[16:19]
    v_mfma_f32_16x16x16_bf16 v[20:23], v[26:27], v[214:215], v[20:23]
    v_mfma_f32_16x16x16_bf16 v[16:19], v[28:29], v[216:217], v[16:19]
    v_mfma_f32_16x16x16_bf16 v[20:23], v[28:29], v[218:219], v[20:23]
    v_mfma_f32_16x16x16_bf16 v[16:19], v[30:31], v[220:221], v[16:19]
    v_mfma_f32_16x16x16_bf16 v[20:23], v[30:31], v[222:223], v[20:23]
    s_waitcnt vmcnt(5)
    buffer_load_dwordx4 v[112:115], v3, s[36:39], s67 offen offset:0 nt
    s_waitcnt vmcnt(5)
    buffer_load_dwordx4 v[116:119], v3, s[36:39], s67 offen offset:1024 nt
    s_waitcnt vmcnt(5)
    buffer_load_dwordx4 v[120:123], v3, s[36:39], s67 offen offset:2048 nt
    s_waitcnt vmcnt(5)
    buffer_load_dwordx4 v[124:127], v3, s[36:39], s67 offen offset:3072 nt
    s_add_u32 s67, s67, 16384
    v_perm_b32 v24, v36, v36, v4
    v_perm_b32 v25, v36, v36, v5
    v_perm_b32 v26, v36, v36, v6
    v_perm_b32 v27, v36, v36, v7
    v_perm_b32 v28, v37, v37, v4
    v_perm_b32 v29, v37, v37, v5
    v_perm_b32 v30, v37, v37, v6
    v_perm_b32 v31, v37, v37, v7
    s_waitcnt vmcnt(12)
    v_mfma_f32_16x16x16_bf16 v[16:19], v[24:25], v[224:225], v[16:19]
    v_mfma_f32_16x16x16_bf16 v[20:23], v[24:25], v[226:227], v[20:23]
    v_mfma_f32_16x16x16_bf16 v[16:19], v[26:27], v[228:229], v[16:19]
    v_mfma_f32_16x16x16_bf16 v[20:23], v[26:27], v[230:231], v[20:23]
    v_mfma_f32_16x16x16_bf16 v[16:19], v[28:29], v[232:233], v[16:19]
    v_mfma_f32_16x16x16_bf16 v[20:23], v[28:29], v[234:235], v[20:23]
    v_mfma_f32_16x16x16_bf16 v[16:19], v[30:31], v[236:237], v[16:19]
    v_mfma_f32_16x16x16_bf16 v[20:23], v[30:31], v[238:239], v[20:23]
    s_waitcnt vmcnt(5)
    buffer_load_dwordx4 v[128:131], v3, s[36:39], s67 offen offset:0 nt
    s_waitcnt vmcnt(5)
    buffer_load_dwordx4 v[132:135], v3, s[36:39], s67 offen offset:1024 nt
    s_waitcnt vmcnt(5)
    buffer_load_dwordx4 v[136:139], v3, s[36:39], s67 offen offset:2048 nt
    s_waitcnt vmcnt(5)
    buffer_load_dwordx4 v[140:143], v3, s[36:39], s67 offen offset:3072 nt
    s_add_u32 s67, s67, 16384
    v_perm_b32 v24, v38, v38, v4
    v_perm_b32 v25, v38, v38, v5
    v_perm_b32 v26, v38, v38, v6
    v_perm_b32 v27, v38, v38, v7
    v_perm_b32 v28, v39, v39, v4
    v_perm_b32 v29, v39, v39, v5
    v_perm_b32 v30, v39, v39, v6
    v_perm_b32 v31, v39, v39, v7
    s_waitcnt vmcnt(12)
    v_mfma_f32_16x16x16_bf16 v[16:19], v[24:25], v[240:241], v[16:19]
    v_mfma_f32_16x16x16_bf16 v[20:23], v[24:25], v[242:243], v[20:23]
    v_mfma_f32_16x16x16_bf16 v[16:19], v[26:27], v[244:245], v[16:19]
    v_mfma_f32_16x16x16_bf16 v[20:23], v[26:27], v[246:247], v[20:23]
    v_mfma_f32_16x16x16_bf16 v[16:19], v[28:29], v[248:249], v[16:19]
    v_mfma_f32_16x16x16_bf16 v[20:23], v[28:29], v[250:251], v[20:23]
    v_mfma_f32_16x16x16_bf16 v[16:19], v[30:31], v[252:253], v[16:19]
    v_mfma_f32_16x16x16_bf16 v[20:23], v[30:31], v[254:255], v[20:23]
    s_waitcnt vmcnt(5)
    buffer_load_dwordx4 v[144:147], v3, s[36:39], s67 offen offset:0 nt
    s_waitcnt vmcnt(5)
    buffer_load_dwordx4 v[148:151], v3, s[36:39], s67 offen offset:1024 nt
    s_waitcnt vmcnt(5)
    buffer_load_dwordx4 v[152:155], v3, s[36:39], s67 offen offset:2048 nt
    s_waitcnt vmcnt(5)
    buffer_load_dwordx4 v[156:159], v3, s[36:39], s67 offen offset:3072 nt
    s_add_u32 s67, s67, 16384
    v_perm_b32 v24, v40, v40, v4
    v_perm_b32 v25, v40, v40, v5
    v_perm_b32 v26, v40, v40, v6
    v_perm_b32 v27, v40, v40, v7
    v_perm_b32 v28, v41, v41, v4
    v_perm_b32 v29, v41, v41, v5
    v_perm_b32 v30, v41, v41, v6
    v_perm_b32 v31, v41, v41, v7
    s_waitcnt vmcnt(12)
    v_mfma_f32_16x16x16_bf16 v[16:19], v[24:25], v[96:97], v[16:19]
    v_mfma_f32_16x16x16_bf16 v[20:23], v[24:25], v[98:99], v[20:23]
    v_mfma_f32_16x16x16_bf16 v[16:19], v[26:27], v[100:101], v[16:19]
    v_mfma_f32_16x16x16_bf16 v[20:23], v[26:27], v[102:103], v[20:23]
    v_mfma_f32_16x16x16_bf16 v[16:19], v[28:29], v[104:105], v[16:19]
    v_mfma_f32_16x16x16_bf16 v[20:23], v[28:29], v[106:107], v[20:23]
    v_mfma_f32_16x16x16_bf16 v[16:19], v[30:31], v[108:109], v[16:19]
    v_mfma_f32_16x16x16_bf16 v[20:23], v[30:31], v[110:111], v[20:23]
    s_waitcnt vmcnt(5)
    buffer_load_dwordx4 v[160:163], v3, s[36:39], s67 offen offset:0 nt
    s_waitcnt vmcnt(5)
    buffer_load_dwordx4 v[164:167], v3, s[36:39], s67 offen offset:1024 nt
    s_waitcnt vmcnt(5)
    buffer_load_dwordx4 v[168:171], v3, s[36:39], s67 offen offset:2048 nt
    s_waitcnt vmcnt(5)
    buffer_load_dwordx4 v[172:175], v3, s[36:39], s67 offen offset:3072 nt
    s_add_u32 s67, s67, 16384
    v_perm_b32 v24, v42, v42, v4
    v_perm_b32 v25, v42, v42, v5
    v_perm_b32 v26, v42, v42, v6
    v_perm_b32 v27, v42, v42, v7
    v_perm_b32 v28, v43, v43, v4
    v_perm_b32 v29, v43, v43, v5
    v_perm_b32 v30, v43, v43, v6
    v_perm_b32 v31, v43, v43, v7
    s_waitcnt vmcnt(12)
    v_mfma_f32_16x16x16_bf16 v[16:19], v[24:25], v[112:113], v[16:19]
    v_mfma_f32_16x16x16_bf16 v[20:23], v[24:25], v[114:115], v[20:23]
    v_mfma_f32_16x16x16_bf16 v[16:19], v[26:27], v[116:117], v[16:19]
    v_mfma_f32_16x16x16_bf16 v[20:23], v[26:27], v[118:119], v[20:23]
    v_mfma_f32_16x16x16_bf16 v[16:19], v[28:29], v[120:121], v[16:19]
    v_mfma_f32_16x16x16_bf16 v[20:23], v[28:29], v[122:123], v[20:23]
    v_mfma_f32_16x16x16_bf16 v[16:19], v[30:31], v[124:125], v[16:19]
    v_mfma_f32_16x16x16_bf16 v[20:23], v[30:31], v[126:127], v[20:23]
    s_waitcnt vmcnt(5)
    buffer_load_dwordx4 v[176:179], v3, s[36:39], s67 offen offset:0 nt
    s_waitcnt vmcnt(5)
    buffer_load_dwordx4 v[180:183], v3, s[36:39], s67 offen offset:1024 nt
    s_waitcnt vmcnt(5)
    buffer_load_dwordx4 v[184:187], v3, s[36:39], s67 offen offset:2048 nt
    s_waitcnt vmcnt(5)
    buffer_load_dwordx4 v[188:191], v3, s[36:39], s67 offen offset:3072 nt
    s_add_u32 s67, s67, 16384
    v_perm_b32 v24, v44, v44, v4
    v_perm_b32 v25, v44, v44, v5
    v_perm_b32 v26, v44, v44, v6
    v_perm_b32 v27, v44, v44, v7
    v_perm_b32 v28, v45, v45, v4
    v_perm_b32 v29, v45, v45, v5
    v_perm_b32 v30, v45, v45, v6
    v_perm_b32 v31, v45, v45, v7
    s_waitcnt vmcnt(12)
    v_mfma_f32_16x16x16_bf16 v[16:19], v[24:25], v[128:129], v[16:19]
    v_mfma_f32_16x16x16_bf16 v[20:23], v[24:25], v[130:131], v[20:23]
    v_mfma_f32_16x16x16_bf16 v[16:19], v[26:27], v[132:133], v[16:19]
    v_mfma_f32_16x16x16_bf16 v[20:23], v[26:27], v[134:135], v[20:23]
    v_mfma_f32_16x16x16_bf16 v[16:19], v[28:29], v[136:137], v[16:19]
    v_mfma_f32_16x16x16_bf16 v[20:23], v[28:29], v[138:139], v[20:23]
    v_mfma_f32_16x16x16_bf16 v[16:19], v[30:31], v[140:141], v[16:19]
    v_mfma_f32_16x16x16_bf16 v[20:23], v[30:31], v[142:143], v[20:23]
    s_waitcnt vmcnt(5)
    buffer_load_dwordx4 v[192:195], v3, s[36:39], s67 offen offset:0 nt
    s_waitcnt vmcnt(5)
    buffer_load_dwordx4 v[196:199], v3, s[36:39], s67 offen offset:1024 nt
    s_waitcnt vmcnt(5)
    buffer_load_dwordx4 v[200:203], v3, s[36:39], s67 offen offset:2048 nt
    s_waitcnt vmcnt(5)
    buffer_load_dwordx4 v[204:207], v3, s[36:39], s67 offen offset:3072 nt
    s_add_u32 s67, s67, 16384
    v_perm_b32 v24, v46, v46, v4
    v_perm_b32 v25, v46, v46, v5
    v_perm_b32 v26, v46, v46, v6
    v_perm_b32 v27, v46, v46, v7
    v_perm_b32 v28, v47, v47, v4
    v_perm_b32 v29, v47, v47, v5
    v_perm_b32 v30, v47, v47, v6
    v_perm_b32 v31, v47, v47, v7
    s_waitcnt vmcnt(12)
    v_mfma_f32_16x16x16_bf16 v[16:19], v[24:25], v[144:145], v[16:19]
    v_mfma_f32_16x16x16_bf16 v[20:23], v[24:25], v[146:147], v[20:23]
    v_mfma_f32_16x16x16_bf16 v[16:19], v[26:27], v[148:149], v[16:19]
    v_mfma_f32_16x16x16_bf16 v[20:23], v[26:27], v[150:151], v[20:23]
    v_mfma_f32_16x16x16_bf16 v[16:19], v[28:29], v[152:153], v[16:19]
    v_mfma_f32_16x16x16_bf16 v[20:23], v[28:29], v[154:155], v[20:23]
    v_mfma_f32_16x16x16_bf16 v[16:19], v[30:31], v[156:157], v[16:19]
    v_mfma_f32_16x16x16_bf16 v[20:23], v[30:31], v[158:159], v[20:23]
    s_waitcnt vmcnt(5)
    buffer_load_dwordx4 v[208:211], v3, s[36:39], s67 offen offset:0 nt
    s_waitcnt vmcnt(5)
    buffer_load_dwordx4 v[212:215], v3, s[36:39], s67 offen offset:1024 nt
    s_waitcnt vmcnt(5)
    buffer_load_dwordx4 v[216:219], v3, s[36:39], s67 offen offset:2048 nt
    s_cmp_lg_u32 s3, 0
    s_cbranch_scc1 L_pg6
    v_mov_b32 v12, 0
    v_mov_b32 v13, 110
    ds_write_b32 v12, v13 offset:5388
L_pg6:
    s_waitcnt vmcnt(5)
    buffer_load_dwordx4 v[220:223], v3, s[36:39], s67 offen offset:3072 nt
    s_add_u32 s67, s67, 16384
    v_perm_b32 v24, v48, v48, v4
    v_perm_b32 v25, v48, v48, v5
    v_perm_b32 v26, v48, v48, v6
    v_perm_b32 v27, v48, v48, v7
    v_perm_b32 v28, v49, v49, v4
    v_perm_b32 v29, v49, v49, v5
    v_perm_b32 v30, v49, v49, v6
    v_perm_b32 v31, v49, v49, v7
    s_waitcnt vmcnt(12)
    v_mfma_f32_16x16x16_bf16 v[16:19], v[24:25], v[160:161], v[16:19]
    v_mfma_f32_16x16x16_bf16 v[20:23], v[24:25], v[162:163], v[20:23]
    v_mfma_f32_16x16x16_bf16 v[16:19], v[26:27], v[164:165], v[16:19]
    v_mfma_f32_16x16x16_bf16 v[20:23], v[26:27], v[166:167], v[20:23]
    v_mfma_f32_16x16x16_bf16 v[16:19], v[28:29], v[168:169], v[16:19]
    v_mfma_f32_16x16x16_bf16 v[20:23], v[28:29], v[170:171], v[20:23]
    v_mfma_f32_16x16x16_bf16 v[16:19], v[30:31], v[172:173], v[16:19]
    v_mfma_f32_16x16x16_bf16 v[20:23], v[30:31], v[174:175], v[20:23]
    s_waitcnt vmcnt(5)
    buffer_load_dwordx4 v[224:227], v3, s[36:39], s67 offen offset:0 nt
    s_waitcnt vmcnt(5)
    buffer_load_dwordx4 v[228:231], v3, s[36:39], s67 offen offset:1024 nt
    s_mov_b32 s44, s28
    s_mov_b32 s45, s29
    s_mov_b32 s46, 1572864
    s_mov_b32 s47, 0x20000
    s_mov_b32 s48, s12
    s_mov_b32 s49, s13
    s_mov_b32 s50, 0x400000
    s_mov_b32 s51, 0x20000
    s_mov_b32 s52, s20
    s_mov_b32 s53, s21
    s_mov_b32 s54, 1835008
    s_mov_b32 s55, 0x20000
    s_waitcnt lgkmcnt(0)
    s_mul_i32 s56, s56, 0x9e3779b5
    s_add_u32 s56, s56, 0x7f4a7c15
    v_lshlrev_b32 v76, 4, v11
    v_lshl_add_u32 v76, v10, 10, v76
    v_cmp_gt_u32 s[68:69], 2, v10
    v_mov_b32 v13, 0x10000000
    s_mul_i32 s58, s31, 14336
    s_lshl_b32 s64, s3, 8
    s_add_u32 s58, s58, s64
    v_cndmask_b32 v77, v13, v76, s[68:69]
    s_lshl_b32 s57, s31, 15
    s_add_u32 s57, s57, s64
    v_lshlrev_b32 v9, 4, v10
    v_lshlrev_b32 v10, 4, v1
    s_mul_i32 s63, s3, 2304
    v_add_u32 v10, s63, v10
    s_lshl_b32 s99, s59, 11
    s_lshl_b32 s63, s3, 9
    s_add_u32 s99, s99, s63
    s_add_u32 s99, s99, 786432
    v_mov_b32 v73, s56
    v_mov_b32 v75, s56
    v_and_b32 v12, 4, v11
    v_cmp_eq_u32 s[68:69], 0, v12
    v_mov_b32 v13, 0x0c0c0c0c
    s_nop 0
    v_cndmask_b32 v80, v13, v4, s[68:69]
    v_cndmask_b32 v82, v4, v13, s[68:69]
    v_cndmask_b32 v81, v13, v5, s[68:69]
    v_cndmask_b32 v83, v5, v13, s[68:69]
    v_cndmask_b32 v84, v13, v6, s[68:69]
    v_cndmask_b32 v86, v6, v13, s[68:69]
    v_cndmask_b32 v85, v13, v7, s[68:69]
    v_cndmask_b32 v87, v7, v13, s[68:69]
    s_waitcnt vmcnt(5)
    buffer_load_dwordx4 v[232:235], v3, s[36:39], s67 offen offset:2048 nt
    s_waitcnt vmcnt(5)
    buffer_load_dwordx4 v[236:239], v3, s[36:39], s67 offen offset:3072 nt
    s_add_u32 s67, s67, 16384
    v_perm_b32 v24, v50, v50, v4
    v_perm_b32 v25, v50, v50, v5
    v_perm_b32 v26, v50, v50, v6
    v_perm_b32 v27, v50, v50, v7
    v_perm_b32 v28, v51, v51, v4
    v_perm_b32 v29, v51, v51, v5
    v_perm_b32 v30, v51, v51, v6
    v_perm_b32 v31, v51, v51, v7
    s_waitcnt vmcnt(12)
    v_mfma_f32_16x16x16_bf16 v[16:19], v[24:25], v[176:177], v[16:19]
    v_mfma_f32_16x16x16_bf16 v[20:23], v[24:25], v[178:179], v[20:23]
    v_mfma_f32_16x16x16_bf16 v[16:19], v[26:27], v[180:181], v[16:19]
    v_mfma_f32_16x16x16_bf16 v[20:23], v[26:27], v[182:183], v[20:23]
    v_mfma_f32_16x16x16_bf16 v[16:19], v[28:29], v[184:185], v[16:19]
    v_mfma_f32_16x16x16_bf16 v[20:23], v[28:29], v[186:187], v[20:23]
    v_mfma_f32_16x16x16_bf16 v[16:19], v[30:31], v[188:189], v[16:19]
    v_mfma_f32_16x16x16_bf16 v[20:23], v[30:31], v[190:191], v[20:23]
    s_waitcnt vmcnt(5)
    buffer_load_dwordx4 v[240:243], v3, s[36:39], s67 offen offset:0 nt
    s_waitcnt vmcnt(5)
    buffer_load_dwordx4 v[244:247], v3, s[36:39], s67 offen offset:1024 nt
    s_waitcnt vmcnt(5)
    buffer_load_dwordx4 v[248:251], v3, s[36:39], s67 offen offset:2048 nt
    s_waitcnt vmcnt(5)
    buffer_load_dwordx4 v[252:255], v3, s[36:39], s67 offen offset:3072 nt
    s_add_u32 s67, s67, 16384
    v_perm_b32 v24, v52, v52, v4
    v_perm_b32 v25, v52, v52, v5
    v_perm_b32 v26, v52, v52, v6
    v_perm_b32 v27, v52, v52, v7
    v_perm_b32 v28, v53, v53, v4
    v_perm_b32 v29, v53, v53, v5
    v_perm_b32 v30, v53, v53, v6
    v_perm_b32 v31, v53, v53, v7
    s_waitcnt vmcnt(12)
    v_mfma_f32_16x16x16_bf16 v[16:19], v[24:25], v[192:193], v[16:19]
    v_mfma_f32_16x16x16_bf16 v[20:23], v[24:25], v[194:195], v[20:23]
    v_mfma_f32_16x16x16_bf16 v[16:19], v[26:27], v[196:197], v[16:19]
    v_mfma_f32_16x16x16_bf16 v[20:23], v[26:27], v[198:199], v[20:23]
    v_mfma_f32_16x16x16_bf16 v[16:19], v[28:29], v[200:201], v[16:19]
    v_mfma_f32_16x16x16_bf16 v[20:23], v[28:29], v[202:203], v[20:23]
    v_mfma_f32_16x16x16_bf16 v[16:19], v[30:31], v[204:205], v[16:19]
    v_mfma_f32_16x16x16_bf16 v[20:23], v[30:31], v[206:207], v[20:23]
    s_waitcnt vmcnt(5)
    buffer_load_dwordx4 v[96:99], v3, s[36:39], s67 offen offset:0 nt
    s_waitcnt vmcnt(5)
    buffer_load_dwordx4 v[100:103], v3, s[36:39], s67 offen offset:1024 nt
    s_waitcnt vmcnt(11)
    buffer_load_dwordx4 v[104:107], v3, s[36:39], s67 offen offset:2048 nt
    s_waitcnt vmcnt(11)
    buffer_load_dwordx4 v[108:111], v3, s[36:39], s67 offen offset:3072 nt
    s_add_u32 s67, s67, 16384
    s_cmp_lg_u32 s3, 0
    s_cbranch_scc1 L_pg7
    v_mov_b32 v12, 0
    v_mov_b32 v13, 123
    ds_write_b32 v12, v13 offset:5388
L_pg7:
    v_perm_b32 v24, v54, v54, v4
    v_perm_b32 v25, v54, v54, v5
    v_perm_b32 v26, v54, v54, v6
    v_perm_b32 v27, v54, v54, v7
    v_perm_b32 v28, v55, v55, v4
    v_perm_b32 v29, v55, v55, v5
    v_perm_b32 v30, v55, v55, v6
    v_perm_b32 v31, v55, v55, v7
    s_waitcnt vmcnt(12)
    v_mfma_f32_16x16x16_bf16 v[16:19], v[24:25], v[208:209], v[16:19]
    v_mfma_f32_16x16x16_bf16 v[20:23], v[24:25], v[210:211], v[20:23]
    v_mfma_f32_16x16x16_bf16 v[16:19], v[26:27], v[212:213], v[16:19]
    v_mfma_f32_16x16x16_bf16 v[20:23], v[26:27], v[214:215], v[20:23]
    v_mfma_f32_16x16x16_bf16 v[16:19], v[28:29], v[216:217], v[16:19]
    v_mfma_f32_16x16x16_bf16 v[20:23], v[28:29], v[218:219], v[20:23]
    v_mfma_f32_16x16x16_bf16 v[16:19], v[30:31], v[220:221], v[16:19]
    v_mfma_f32_16x16x16_bf16 v[20:23], v[30:31], v[222:223], v[20:23]
    s_waitcnt vmcnt(11)
    buffer_load_dwordx4 v[112:115], v3, s[36:39], s67 offen offset:0 nt
    s_waitcnt vmcnt(11)
    buffer_load_dwordx4 v[116:119], v3, s[36:39], s67 offen offset:1024 nt
    s_waitcnt vmcnt(11)
    buffer_load_dwordx4 v[120:123], v3, s[36:39], s67 offen offset:2048 nt
    s_waitcnt vmcnt(11)
    buffer_load_dwordx4 v[124:127], v3, s[36:39], s67 offen offset:3072 nt
    v_perm_b32 v24, v56, v56, v4
    v_perm_b32 v25, v56, v56, v5
    v_perm_b32 v26, v56, v56, v6
    v_perm_b32 v27, v56, v56, v7
    v_perm_b32 v28, v57, v57, v4
    v_perm_b32 v29, v57, v57, v5
    v_perm_b32 v30, v57, v57, v6
    v_perm_b32 v31, v57, v57, v7
    s_waitcnt vmcnt(12)
    v_mfma_f32_16x16x16_bf16 v[16:19], v[24:25], v[224:225], v[16:19]
    v_mfma_f32_16x16x16_bf16 v[20:23], v[24:25], v[226:227], v[20:23]
    v_mfma_f32_16x16x16_bf16 v[16:19], v[26:27], v[228:229], v[16:19]
    v_mfma_f32_16x16x16_bf16 v[20:23], v[26:27], v[230:231], v[20:23]
    v_mfma_f32_16x16x16_bf16 v[16:19], v[28:29], v[232:233], v[16:19]
    v_mfma_f32_16x16x16_bf16 v[20:23], v[28:29], v[234:235], v[20:23]
    v_mfma_f32_16x16x16_bf16 v[16:19], v[30:31], v[236:237], v[16:19]
    v_mfma_f32_16x16x16_bf16 v[20:23], v[30:31], v[238:239], v[20:23]
    v_perm_b32 v24, v58, v58, v4
    v_perm_b32 v25, v58, v58, v5
    v_perm_b32 v26, v58, v58, v6
    v_perm_b32 v27, v58, v58, v7
    v_perm_b32 v28, v59, v59, v4
    v_perm_b32 v29, v59, v59, v5
    v_perm_b32 v30, v59, v59, v6
    v_perm_b32 v31, v59, v59, v7
    s_waitcnt vmcnt(8)
    v_mfma_f32_16x16x16_bf16 v[16:19], v[24:25], v[240:241], v[16:19]
    v_mfma_f32_16x16x16_bf16 v[20:23], v[24:25], v[242:243], v[20:23]
    v_mfma_f32_16x16x16_bf16 v[16:19], v[26:27], v[244:245], v[16:19]
    v_mfma_f32_16x16x16_bf16 v[20:23], v[26:27], v[246:247], v[20:23]
    v_mfma_f32_16x16x16_bf16 v[16:19], v[28:29], v[248:249], v[16:19]
    v_mfma_f32_16x16x16_bf16 v[20:23], v[28:29], v[250:251], v[20:23]
    v_mfma_f32_16x16x16_bf16 v[16:19], v[30:31], v[252:253], v[16:19]
    v_mfma_f32_16x16x16_bf16 v[20:23], v[30:31], v[254:255], v[20:23]
    v_perm_b32 v24, v60, v60, v4
    v_perm_b32 v25, v60, v60, v5
    v_perm_b32 v26, v60, v60, v6
    v_perm_b32 v27, v60, v60, v7
    v_perm_b32 v28, v61, v61, v4
    v_perm_b32 v29, v61, v61, v5
    v_perm_b32 v30, v61, v61, v6
    v_perm_b32 v31, v61, v61, v7
    s_waitcnt vmcnt(4)
    v_mfma_f32_16x16x16_bf16 v[16:19], v[24:25], v[96:97], v[16:19]
    v_mfma_f32_16x16x16_bf16 v[20:23], v[24:25], v[98:99], v[20:23]
    v_mfma_f32_16x16x16_bf16 v[16:19], v[26:27], v[100:101], v[16:19]
    v_mfma_f32_16x16x16_bf16 v[20:23], v[26:27], v[102:103], v[20:23]
    v_mfma_f32_16x16x16_bf16 v[16:19], v[28:29], v[104:105], v[16:19]
    v_mfma_f32_16x16x16_bf16 v[20:23], v[28:29], v[106:107], v[20:23]
    v_mfma_f32_16x16x16_bf16 v[16:19], v[30:31], v[108:109], v[16:19]
    v_mfma_f32_16x16x16_bf16 v[20:23], v[30:31], v[110:111], v[20:23]
    v_perm_b32 v24, v62, v62, v4
    v_perm_b32 v25, v62, v62, v5
    v_perm_b32 v26, v62, v62, v6
    v_perm_b32 v27, v62, v62, v7
    v_perm_b32 v28, v63, v63, v4
    v_perm_b32 v29, v63, v63, v5
    v_perm_b32 v30, v63, v63, v6
    v_perm_b32 v31, v63, v63, v7
    s_waitcnt vmcnt(3)
    v_mfma_f32_16x16x16_bf16 v[16:19], v[24:25], v[112:113], v[16:19]
    v_mfma_f32_16x16x16_bf16 v[20:23], v[24:25], v[114:115], v[20:23]
    s_waitcnt vmcnt(2)
    v_mfma_f32_16x16x16_bf16 v[16:19], v[26:27], v[116:117], v[16:19]
    v_mfma_f32_16x16x16_bf16 v[20:23], v[26:27], v[118:119], v[20:23]
    s_waitcnt vmcnt(1)
    v_mfma_f32_16x16x16_bf16 v[16:19], v[28:29], v[120:121], v[16:19]
    v_mfma_f32_16x16x16_bf16 v[20:23], v[28:29], v[122:123], v[20:23]
    buffer_load_dwordx4 v[160:163], v76, s[52:55], s58 offen
    s_add_u32 s58, s58, 4096
    buffer_load_dwordx4 v[164:167], v76, s[52:55], s58 offen
    s_add_u32 s58, s58, 4096
    buffer_load_dwordx4 v[168:171], v76, s[52:55], s58 offen
    s_add_u32 s58, s58, 4096
    buffer_load_dwordx4 v[172:175], v77, s[52:55], s58 offen
    s_waitcnt vmcnt(4)
    v_mfma_f32_16x16x16_bf16 v[16:19], v[30:31], v[124:125], v[16:19]
    v_mfma_f32_16x16x16_bf16 v[20:23], v[30:31], v[126:127], v[20:23]
    s_nop 6
    ds_write_b128 v10, v[16:19] offset:6400
    ds_write_b128 v10, v[20:23] offset:7552
    s_waitcnt lgkmcnt(0)
    s_barrier
    s_barrier
    buffer_load_dwordx4 v[128:131], v76, s[48:51], s57 offen
    s_add_u32 s57, s57, 4096
    buffer_load_dwordx4 v[132:135], v76, s[48:51], s57 offen
    s_add_u32 s57, s57, 4096
    buffer_load_dwordx4 v[136:139], v76, s[48:51], s57 offen
    s_add_u32 s57, s57, 4096
    buffer_load_dwordx4 v[140:143], v76, s[48:51], s57 offen
    s_add_u32 s57, s57, 4096
    buffer_load_dwordx4 v[144:147], v76, s[48:51], s57 offen
    s_add_u32 s57, s57, 4096
    buffer_load_dwordx4 v[148:151], v76, s[48:51], s57 offen
    s_add_u32 s57, s57, 4096
    buffer_load_dwordx4 v[152:155], v76, s[48:51], s57 offen
    s_add_u32 s57, s57, 4096
    buffer_load_dwordx4 v[156:159], v76, s[48:51], s57 offen
    ds_read_b128 v[192:195], v9 offset:5312
    v_lshlrev_b32 v9, 1, v9
    s_waitcnt lgkmcnt(0)
    v_cvt_pk_bf16_f32 v196, v192, v193
    v_cvt_pk_bf16_f32 v197, v194, v195
    v_perm_b32 v24, v196, v196, v80
    v_perm_b32 v25, v196, v196, v81
    v_perm_b32 v26, v196, v196, v82
    v_perm_b32 v27, v196, v196, v83
    v_perm_b32 v28, v196, v196, v84
    v_perm_b32 v29, v196, v196, v85
    v_perm_b32 v30, v196, v196, v86
    v_perm_b32 v31, v196, v196, v87
    s_waitcnt vmcnt(8)
    v_mfma_f32_16x16x32_bf16 v[64:67], v[24:27], v[160:163], 0
    v_perm_b32 v24, v197, v197, v80
    v_perm_b32 v25, v197, v197, v81
    v_perm_b32 v26, v197, v197, v82
    v_perm_b32 v27, v197, v197, v83
    v_mfma_f32_16x16x32_bf16 v[64:67], v[28:31], v[164:167], v[64:67]
    v_perm_b32 v28, v197, v197, v84
    v_perm_b32 v29, v197, v197, v85
    v_perm_b32 v30, v197, v197, v86
    v_perm_b32 v31, v197, v197, v87
    v_mfma_f32_16x16x32_bf16 v[64:67], v[24:27], v[168:171], v[64:67]
    s_nop 0
    v_mfma_f32_16x16x32_bf16 v[64:67], v[28:31], v[172:175], v[64:67]
    s_waitcnt vmcnt(0)
    s_barrier
    ds_read_b128 v[200:203], v9 offset:5632
    ds_read_b128 v[204:207], v9 offset:5760
    ds_read_b128 v[208:211], v9 offset:5648
    ds_read_b128 v[212:215], v9 offset:5776
    s_waitcnt lgkmcnt(2)
    v_add_f32 v200, v200, v204
    v_add_f32 v201, v201, v205
    v_cvt_pk_bf16_f32 v192, v200, v201
    v_perm_b32 v24, v192, v192, v80
    v_perm_b32 v25, v192, v192, v81
    v_perm_b32 v26, v192, v192, v82
    v_perm_b32 v27, v192, v192, v83
    v_add_f32 v202, v202, v206
    v_add_f32 v203, v203, v207
    v_cvt_pk_bf16_f32 v193, v202, v203
    v_mfma_f32_16x16x32_bf16 v[64:67], v[24:27], v[128:131], v[64:67]
    v_perm_b32 v28, v192, v192, v84
    v_perm_b32 v29, v192, v192, v85
    v_perm_b32 v30, v192, v192, v86
    v_perm_b32 v31, v192, v192, v87
    v_perm_b32 v24, v193, v193, v80
    v_perm_b32 v25, v193, v193, v81
    v_perm_b32 v26, v193, v193, v82
    v_perm_b32 v27, v193, v193, v83
    v_mfma_f32_16x16x32_bf16 v[64:67], v[28:31], v[132:135], v[64:67]
    s_waitcnt lgkmcnt(0)
    v_add_f32 v208, v208, v212
    v_add_f32 v209, v209, v213
    v_cvt_pk_bf16_f32 v194, v208, v209
    v_mfma_f32_16x16x32_bf16 v[64:67], v[24:27], v[136:139], v[64:67]
    v_perm_b32 v28, v193, v193, v84
    v_perm_b32 v29, v193, v193, v85
    v_perm_b32 v30, v193, v193, v86
    v_perm_b32 v31, v193, v193, v87
    v_perm_b32 v24, v194, v194, v80
    v_perm_b32 v25, v194, v194, v81
    v_perm_b32 v26, v194, v194, v82
    v_perm_b32 v27, v194, v194, v83
    v_mfma_f32_16x16x32_bf16 v[64:67], v[28:31], v[140:143], v[64:67]
    v_add_f32 v210, v210, v214
    v_add_f32 v211, v211, v215
    v_cvt_pk_bf16_f32 v195, v210, v211
    v_mfma_f32_16x16x32_bf16 v[64:67], v[24:27], v[144:147], v[64:67]
    v_perm_b32 v28, v194, v194, v84
    v_perm_b32 v29, v194, v194, v85
    v_perm_b32 v30, v194, v194, v86
    v_perm_b32 v31, v194, v194, v87
    v_perm_b32 v24, v195, v195, v80
    v_perm_b32 v25, v195, v195, v81
    v_perm_b32 v26, v195, v195, v82
    v_perm_b32 v27, v195, v195, v83
    v_mfma_f32_16x16x32_bf16 v[64:67], v[28:31], v[148:151], v[64:67]
    v_perm_b32 v28, v195, v195, v84
    v_perm_b32 v29, v195, v195, v85
    v_perm_b32 v30, v195, v195, v86
    v_perm_b32 v31, v195, v195, v87
    v_mfma_f32_16x16x32_bf16 v[64:67], v[24:27], v[152:155], v[64:67]
    s_nop 0
    v_mfma_f32_16x16x32_bf16 v[64:67], v[28:31], v[156:159], v[64:67]
    s_nop 6
    s_mov_b32 exec_hi, 0
    v_cvt_pk_bf16_f32 v72, v64, v65
    v_cvt_pk_bf16_f32 v74, v66, v67
    buffer_store_dwordx4 v[72:75], v3, s[44:47], s99 offen sc1
    s_mov_b64 exec, -1
    s_branch L_join
L_helper:
    v_mov_b32 v12, 0
    v_mov_b32 v13, 0
    v_mov_b32 v14, 0
    v_mov_b32 v15, 0
    ds_write_b128 v12, v[12:15] offset:5376
    s_waitcnt lgkmcnt(0)
    s_load_dword s56, s[28:29], 0
    s_barrier
    s_mov_b32 s44, s28
    s_mov_b32 s45, s29
    s_mov_b32 s46, 1572864
    s_mov_b32 s47, 0x20000
    s_mov_b32 s48, s12
    s_mov_b32 s49, s13
    s_mov_b32 s50, 0x400000
    s_mov_b32 s51, 0x20000
    s_mov_b32 s52, s20
    s_mov_b32 s53, s21
    s_mov_b32 s54, 1835008
    s_mov_b32 s55, 0x20000
    s_cmp_lg_u32 s3, 5
    s_cbranch_scc1 L_nox
    s_lshl_b32 s63, s30, 10
    v_add_u32 v9, s63, v3
    global_load_dwordx4 v[32:35], v9, s[4:5]
    global_load_dwordx4 v[36:39], v3, s[22:23]
    s_waitcnt vmcnt(0)
    v_dot2_f32_bf16 v8, v32, v36, 0
    v_dot2_f32_bf16 v8, v33, v37, v8
    v_dot2_f32_bf16 v8, v34, v38, v8
    v_dot2_f32_bf16 v8, v35, v39, v8
    s_nop 2
    v_add_f32_dpp v8, v8, v8 quad_perm:[1,0,3,2] row_mask:0xf bank_mask:0xf
    s_nop 1
    v_add_f32_dpp v8, v8, v8 quad_perm:[2,3,0,1] row_mask:0xf bank_mask:0xf
    s_nop 1
    v_add_f32_dpp v8, v8, v8 row_half_mirror row_mask:0xf bank_mask:0xf
    s_nop 1
    v_add_f32_dpp v8, v8, v8 row_mirror row_mask:0xf bank_mask:0xf
    s_nop 1
    v_mov_b32 v9, v8
    s_nop 1
    v_permlane16_swap_b32 v9, v8
    v_add_f32 v8, v9, v8
    v_mov_b32 v9, v8
    s_nop 1
    v_permlane32_swap_b32 v9, v8
    v_add_f32 v8, v9, v8
    v_mul_f32 v8, 0xbfb8aa3b, v8
    v_exp_f32 v8, v8
    s_nop 0
    v_add_f32 v8, 1.0, v8
    v_rcp_f32 v8, v8
L_nox:
    s_waitcnt lgkmcnt(0)
    s_mul_i32 s56, s56, 0x9e3779b5
    s_add_u32 s56, s56, 0x7f4a7c15
    s_cmp_lg_u32 s3, 4
    s_cbranch_scc1 L_noA2
    s_cmp_ge_u32 s31, 120
    s_cbranch_scc1 L_noA2
    v_and_b32 v14, 31, v1
    v_lshlrev_b32 v9, 4, v14
    v_lshrrev_b32 v15, 5, v1
    v_lshl_add_u32 v9, v15, 3, v9
    v_lshrrev_b32 v14, 4, v14
    v_mul_u32_u24 v14, 30464, v14
    v_add_u32 v14, v14, v3
    s_mul_i32 s64, s30, 61440
    s_lshl_b32 s65, s31, 8
    s_add_u32 s64, s64, s65
    s_add_u32 s64, s64, 4096
    v_mov_b32 v12, 0
    s_mov_b32 s62, 0
    s_branch L_lw8_n
L_lw8:
    s_sleep 1
L_lw8_n:
    ds_read_b32 v13, v12 offset:5376
    s_add_u32 s62, s62, 1
    s_cmp_gt_u32 s62, 16000000
    s_cbranch_scc1 L_bail
    s_waitcnt lgkmcnt(0)
    v_readfirstlane_b32 s63, v13
    s_cmp_lt_u32 s63, 4
    s_cbranch_scc1 L_lw8
    ds_read_b64 v[32:33], v9 offset:0
    ds_read_b64 v[34:35], v9 offset:1024
    ds_read_b64 v[36:37], v9 offset:2048
    ds_read_b64 v[38:39], v9 offset:3072
    s_waitcnt lgkmcnt(0)
    v_pk_add_f32 v[32:33], v[32:33], v[34:35]
    v_pk_add_f32 v[36:37], v[36:37], v[38:39]
    v_pk_add_f32 v[32:33], v[32:33], v[36:37]
    v_cvt_pk_bf16_f32 v36, v32, v33
    v_cvt_pk_bf16_f32 v38, v32, v33
    v_mov_b32 v37, s56
    v_mov_b32 v39, s56
    v_permlane32_swap_b32 v36, v38
    s_mov_b32 exec_hi, 0
    buffer_store_dwordx4 v[36:39], v14, s[44:47], s64 offen sc1
    s_mov_b32 exec_hi, -1
L_noA2:
    v_lshrrev_b32 v40, 5, v1
    v_mul_u32_u24 v40, 60928, v40
    v_add_u32 v40, v40, v3
    s_mul_i32 s98, s30, 30720
    s_lshr_b32 s64, s31, 4
    s_lshl_b32 s64, s64, 11
    s_add_u32 s98, s98, s64
    s_and_b32 s65, s3, 3
    s_lshl_b32 s64, s65, 9
    s_add_u32 s98, s98, s64
    s_add_u32 s98, s98, 4096
    v_mov_b32 v12, 0
    s_mov_b32 s62, 0
    s_branch L_lw9_n
L_lw9:
    s_sleep 2
L_lw9_n:
    ds_read_b32 v13, v12 offset:5388
    s_add_u32 s62, s62, 1
    s_cmp_gt_u32 s62, 16000000
    s_cbranch_scc1 L_bail
    s_waitcnt lgkmcnt(0)
    v_readfirstlane_b32 s63, v13
    s_cmp_lt_u32 s63, 30
    s_cbranch_scc1 L_lw9
    s_mov_b32 s62, 0
    s_branch L_spin10_n
L_spin10:
    s_sleep 4
L_spin10_n:
    buffer_load_dwordx4 v[32:35], v40, s[44:47], s98 offen sc1
    s_add_u32 s62, s62, 1
    s_cmp_gt_u32 s62, 2000000
    s_cbranch_scc1 L_bail
L_chk11:
    s_waitcnt vmcnt(0)
    v_cmp_ne_u32 vcc, s56, v33
    v_cmp_ne_u32 s[68:69], s56, v35
    s_or_b64 vcc, vcc, s[68:69]
    s_wqm_b64 exec, vcc
    s_cbranch_scc1 L_spin10
    s_mov_b64 exec, -1
    v_mov_b32 v36, v32
    v_mov_b32 v37, v34
    s_lshl_b32 s63, s65, 8
    s_add_u32 s63, s63, 4096
    v_permlane32_swap_b32 v36, v32
    v_permlane32_swap_b32 v37, v34
    v_lshlrev_b32 v12, 16, v36
    v_lshlrev_b32 v13, 16, v32
    v_and_b32 v14, 0xffff0000, v36
    v_and_b32 v15, 0xffff0000, v32
    v_add_f32 v12, v12, v13
    v_add_f32 v14, v14, v15
    v_cvt_pk_bf16_f32 v36, v12, v14
    v_lshlrev_b32 v12, 16, v37
    v_lshlrev_b32 v13, 16, v34
    v_and_b32 v14, 0xffff0000, v37
    v_and_b32 v15, 0xffff0000, v34
    v_add_f32 v12, v12, v13
    v_add_f32 v14, v14, v15
    v_cvt_pk_bf16_f32 v37, v12, v14
    v_and_b32 v9, 31, v1
    v_lshl_add_u32 v9, v9, 3, s63
    ds_write2_b32 v9, v36, v37 offset0:0 offset1:1
    v_mov_b32 v12, 0
    v_mov_b32 v13, 1
    s_mov_b64 exec, 1
    ds_add_u32 v12, v13 offset:5384
    s_mov_b64 exec, -1
    v_mov_b32 v12, 0
    s_mov_b32 s62, 0
    s_branch L_lw12_n
L_lw12:
    s_sleep 2
L_lw12_n:
    ds_read_b32 v13, v12 offset:5388
    s_add_u32 s62, s62, 1
    s_cmp_gt_u32 s62, 16000000
    s_cbranch_scc1 L_bail
    s_waitcnt lgkmcnt(0)
    v_readfirstlane_b32 s63, v13
    s_cmp_lt_u32 s63, 50
    s_cbranch_scc1 L_lw12
    s_lshl_b32 s63, s59, 11
    s_and_b32 s64, s3, 1
    s_lshl_b32 s64, s64, 10
    s_add_u32 s63, s63, s64
    s_add_u32 s63, s63, 262144
    s_and_b32 s64, s3, 2
    s_mul_i32 s64, s64, 262144
    s_add_u32 s63, s63, s64
    buffer_load_dwordx4 v[212:215], v3, s[44:47], s63 offen sc1
    s_cmp_lg_u32 s3, 5
    s_cbranch_scc1 L_noside
    v_min_u32 v40, 13, v11
    v_lshrrev_b32 v40, 1, v40
    v_lshlrev_b32 v40, 3, v40
    s_mul_i32 s63, s31, 7
    s_mul_i32 s64, s30, 3840
    s_add_u32 s63, s63, s64
    s_lshl_b32 s63, s63, 3
    s_add_u32 s63, s63, 20480
    v_and_b32 v41, 1, v10
    v_mul_u32_u24 v41, 61440, v41
    v_lshrrev_b32 v42, 1, v10
    v_mul_u32_u24 v42, 7168, v42
    v_add3_u32 v40, v40, v41, v42
    v_add_u32 v40, s63, v40
    s_mov_b32 s62, 0
    s_branch L_spin13_n
L_spin13:
    s_sleep 4
L_spin13_n:
    buffer_load_dwordx2 v[32:33], v40, s[44:47], 0 offen sc1
    s_add_u32 s62, s62, 1
    s_cmp_gt_u32 s62, 2000000
    s_cbranch_scc1 L_bail
L_chk14:
    s_waitcnt vmcnt(0)
    v_cmp_ne_u32 vcc, s56, v33
    s_wqm_b64 exec, vcc
    s_cbranch_scc1 L_spin13
    s_mov_b64 exec, -1
    v_and_b32 v34, 1, v1
    v_cmp_eq_u32 vcc, 1, v34
    v_lshlrev_b32 v34, 16, v32
    v_and_b32 v35, 0xffff0000, v32
    v_cndmask_b32 v34, v34, v35, vcc
    v_cmp_gt_u32 vcc, 14, v11
    v_mov_b32 v35, v34
    s_nop 1
    v_permlane16_swap_b32 v35, v34
    v_add_f32 v34, v34, v35
    v_mov_b32 v36, v34
    s_nop 1
    v_permlane32_swap_b32 v34, v36
    v_mul_f32 v34, 0xbfb8aa3b, v34
    v_exp_f32 v34, v34
    v_sub_f32 v37, 1.0, v8
    v_add_f32 v34, 1.0, v34
    v_rcp_f32 v34, v34
    v_mul_f32 v36, v36, v37
    v_mul_f32 v34, v34, v36
    v_cndmask_b32 v34, 0, v34, vcc
    v_and_b32 v35, 3, v11
    v_lshlrev_b32 v35, 4, v35
    v_and_b32 v36, 12, v11
    v_add_u32 v35, v36, v35
    ds_write_b32 v35, v34 offset:5312
    v_and_b32 v40, 3, v1
    v_lshlrev_b32 v40, 4, v40
    v_bfe_u32 v41, v1, 2, 1
    v_lshl_add_u32 v41, v41, 6, v40
    s_lshl_b32 s64, s59, 7
    s_add_u32 s64, s64, 131072
    v_mov_b32 v45, s56
    v_mov_b32 v47, s56
    v_mov_b32 v12, 0
    s_mov_b32 s62, 0
    s_branch L_lw15_n
L_lw15:
    s_sleep 2
L_lw15_n:
    ds_read_b32 v13, v12 offset:5380
    s_add_u32 s62, s62, 1
    s_cmp_gt_u32 s62, 16000000
    s_cbranch_scc1 L_bail
    s_waitcnt lgkmcnt(0)
    v_readfirstlane_b32 s63, v13
    s_cmp_lt_u32 s63, 4
    s_cbranch_scc1 L_lw15
    ds_read_b128 v[32:35], v40 offset:5120
    ds_read_b128 v[36:39], v40 offset:5184
    v_and_b32 v42, 12, v1
    v_add_u32 v42, v42, v40
    ds_read_b32 v43, v42 offset:5120
    s_waitcnt lgkmcnt(0)
    v_max3_f32 v44, v32, v33, v34
    v_max_f32 v44, v44, v35
    v_sub_f32 v32, v32, v44
    v_sub_f32 v33, v33, v44
    v_sub_f32 v34, v34, v44
    v_sub_f32 v35, v35, v44
    v_exp_f32 v32, v32
    v_exp_f32 v33, v33
    v_exp_f32 v34, v34
    v_exp_f32 v35, v35
    v_mul_f32 v46, v32, v36
    v_fmac_f32 v46, v33, v37
    v_fmac_f32 v46, v34, v38
    v_fmac_f32 v46, v35, v39
    s_mov_b64 exec, 0xff
    buffer_store_dwordx4 v[44:47], v41, s[44:47], s64 offen sc1
    s_mov_b64 exec, -1
    s_and_b32 s64, s59, 0xf0
    s_lshl_b32 s64, s64, 7
    s_add_u32 s64, s64, 131072
    v_lshrrev_b32 v41, 2, v1
    v_lshl_add_u32 v41, v41, 7, v40
    v_mov_b32 v12, 0
    s_mov_b32 s62, 0
    s_branch L_lw16_n
L_lw16:
    s_sleep 2
L_lw16_n:
    ds_read_b32 v13, v12 offset:5388
    s_add_u32 s62, s62, 1
    s_cmp_gt_u32 s62, 16000000
    s_cbranch_scc1 L_bail
    s_waitcnt lgkmcnt(0)
    v_readfirstlane_b32 s63, v13
    s_cmp_lt_u32 s63, 110
    s_cbranch_scc1 L_lw16
    s_mov_b32 s62, 0
    s_branch L_spin17_n
L_spin17:
    s_sleep 4
L_spin17_n:
    buffer_load_dwordx4 v[32:35], v41, s[44:47], s64 offen sc1
    s_add_u32 s62, s62, 1
    s_cmp_gt_u32 s62, 2000000
    s_cbranch_scc1 L_bail
L_chk18:
    s_waitcnt vmcnt(0)
    v_cmp_ne_u32 vcc, s56, v33
    v_cmp_ne_u32 s[68:69], s56, v35
    s_or_b64 vcc, vcc, s[68:69]
    s_wqm_b64 exec, vcc
    s_cbranch_scc1 L_spin17
    s_mov_b64 exec, -1
    v_mov_b32 v36, v32
    s_nop 1
    v_max_f32_dpp v36, v36, v36 row_ror:4 row_mask:0xf bank_mask:0xf
    s_nop 1
    v_max_f32_dpp v36, v36, v36 row_ror:8 row_mask:0xf bank_mask:0xf
    s_nop 1
    v_mov_b32 v37, v36
    s_nop 1
    v_permlane16_swap_b32 v37, v36
    v_max_f32 v36, v37, v36
    v_mov_b32 v37, v36
    s_nop 1
    v_permlane32_swap_b32 v37, v36
    v_max_f32 v36, v37, v36
    v_sub_f32 v37, v32, v36
    v_exp_f32 v37, v37
    s_nop 0
    v_mul_f32 v37, v37, v34
    s_nop 1
    v_add_f32_dpp v37, v37, v37 row_ror:4 row_mask:0xf bank_mask:0xf
    s_nop 1
    v_add_f32_dpp v37, v37, v37 row_ror:8 row_mask:0xf bank_mask:0xf
    s_nop 1
    v_mov_b32 v38, v37
    s_nop 1
    v_permlane16_swap_b32 v38, v37
    v_add_f32 v37, v38, v37
    v_mov_b32 v38, v37
    s_nop 1
    v_permlane32_swap_b32 v38, v37
    v_add_f32 v37, v38, v37
    v_sub_f32 v43, v43, v36
    v_rcp_f32 v37, v37
    v_exp_f32 v43, v43
    v_mul_f32 v37, v37, v8
    v_mul_f32 v43, v43, v37
    ds_write_b32 v42, v43 offset:5248
L_noside:
    s_cmp_lg_u32 s2, 255
    s_cbranch_scc1 L_noep
    s_cmp_lg_u32 s3, 7
    s_cbranch_scc1 L_noep
    v_lshlrev_b32 v48, 9, v1
    s_mov_b32 s64, 131072
    v_mov_b32 v12, 0
    s_mov_b32 s62, 0
    s_branch L_lw19_n
L_lw19:
    s_sleep 2
L_lw19_n:
    ds_read_b32 v13, v12 offset:5388
    s_add_u32 s62, s62, 1
    s_cmp_gt_u32 s62, 16000000
    s_cbranch_scc1 L_bail
    s_waitcnt lgkmcnt(0)
    v_readfirstlane_b32 s63, v13
    s_cmp_lt_u32 s63, 123
    s_cbranch_scc1 L_lw19
    s_mov_b32 s62, 0
    s_branch L_spin20_n
L_spin20:
    s_sleep 8
L_spin20_n:
    buffer_load_dwordx4 v[32:35], v48, s[44:47], s64 offen offset:0 sc1
    buffer_load_dwordx4 v[36:39], v48, s[44:47], s64 offen offset:128 sc1
    buffer_load_dwordx4 v[40:43], v48, s[44:47], s64 offen offset:256 sc1
    buffer_load_dwordx4 v[44:47], v48, s[44:47], s64 offen offset:384 sc1
    s_add_u32 s62, s62, 1
    s_cmp_gt_u32 s62, 2000000
    s_cbranch_scc1 L_bail
L_chk21:
    s_waitcnt vmcnt(0)
    v_cmp_ne_u32 vcc, s56, v33
    v_cmp_ne_u32 s[68:69], s56, v35
    s_or_b64 vcc, vcc, s[68:69]
    v_cmp_ne_u32 s[68:69], s56, v37
    s_or_b64 vcc, vcc, s[68:69]
    v_cmp_ne_u32 s[68:69], s56, v39
    s_or_b64 vcc, vcc, s[68:69]
    v_cmp_ne_u32 s[68:69], s56, v41
    s_or_b64 vcc, vcc, s[68:69]
    v_cmp_ne_u32 s[68:69], s56, v43
    s_or_b64 vcc, vcc, s[68:69]
    v_cmp_ne_u32 s[68:69], s56, v45
    s_or_b64 vcc, vcc, s[68:69]
    v_cmp_ne_u32 s[68:69], s56, v47
    s_or_b64 vcc, vcc, s[68:69]
    s_wqm_b64 exec, vcc
    s_cbranch_scc1 L_spin20
    s_mov_b64 exec, -1
    v_mov_b32 v48, 0
    v_mov_b32 v49, s56
    s_mov_b64 exec, 1
    buffer_store_dword v49, v48, s[44:47], 0 offen sc1
    s_mov_b64 exec, -1
L_noep:
    v_lshrrev_b32 v9, 3, v1
    v_and_b32 v12, 7, v1
    s_and_b32 s65, s3, 1
    v_lshlrev_b32 v10, 5, v10
    v_lshl_add_u32 v10, v12, 2, v10
    s_lshl_b32 s63, s65, 7
    v_add_u32 v10, s63, v10
    v_lshrrev_b32 v11, 1, v1
    v_lshlrev_b32 v11, 4, v11
    v_and_b32 v13, 1, v1
    v_mul_u32_u24 v13, 1152, v13
    s_lshl_b32 s63, s65, 9
    v_add3_u32 v11, v11, v13, s63
    v_lshrrev_b32 v14, 5, v1
    v_lshlrev_b32 v14, 4, v14
    s_lshl_b32 s63, s65, 5
    v_add_u32 v14, s63, v14
    s_lshl_b32 s99, s59, 11
    s_lshl_b32 s63, s65, 10
    s_add_u32 s99, s99, s63
    s_add_u32 s99, s99, 262144
    v_lshlrev_b32 v15, 11, v9
    v_lshl_add_u32 v15, v12, 4, v15
    s_and_b32 s100, s59, 0xf0
    s_lshl_b32 s63, s65, 3
    s_add_u32 s100, s100, s63
    s_lshl_b32 s100, s100, 11
    s_and_b32 s63, s31, 15
    s_lshl_b32 s63, s63, 7
    s_add_u32 s100, s100, s63
    s_add_u32 s100, s100, 262144
    v_mov_b32 v73, s56
    v_mov_b32 v75, s56
    s_waitcnt lgkmcnt(0)
    s_barrier
    s_cmp_ge_u32 s3, 6
    s_cbranch_scc1 L_gather
    ds_read_b128 v[208:211], v14 offset:5248
    ds_read_b128 v[192:195], v11 offset:6400
    ds_read_b128 v[196:199], v11 offset:8704
    ds_read_b128 v[200:203], v11 offset:11008
    ds_read_b128 v[204:207], v11 offset:13312
    s_waitcnt lgkmcnt(3)
    v_mul_f32 v192, v192, v208
    v_mul_f32 v193, v193, v208
    v_mul_f32 v194, v194, v208
    v_mul_f32 v195, v195, v208
    s_waitcnt lgkmcnt(2)
    v_fmac_f32 v192, v196, v209
    v_fmac_f32 v193, v197, v209
    v_fmac_f32 v194, v198, v209
    v_fmac_f32 v195, v199, v209
    s_waitcnt lgkmcnt(1)
    v_fmac_f32 v192, v200, v210
    v_fmac_f32 v193, v201, v210
    v_fmac_f32 v194, v202, v210
    v_fmac_f32 v195, v203, v210
    s_waitcnt lgkmcnt(0)
    v_fmac_f32 v192, v204, v211
    v_fmac_f32 v193, v205, v211
    v_fmac_f32 v194, v206, v211
    v_fmac_f32 v195, v207, v211
    v_cvt_pk_bf16_f32 v72, v192, v193
    v_cvt_pk_bf16_f32 v74, v194, v195
    buffer_store_dwordx4 v[72:75], v3, s[44:47], s99 offen sc1
    s_barrier
    s_barrier
    s_branch L_join
L_gather:
    buffer_load_dwordx4 v[192:195], v15, s[44:47], s100 offen sc1
    s_barrier
    s_mov_b32 s62, 0
    s_branch L_chk23
L_spin22:
    buffer_load_dwordx4 v[192:195], v15, s[44:47], s100 offen sc1
    s_add_u32 s62, s62, 1
    s_cmp_gt_u32 s62, 2000000
    s_cbranch_scc1 L_bail
L_chk23:
    s_waitcnt vmcnt(0)
    v_cmp_ne_u32 vcc, s56, v193
    v_cmp_ne_u32 s[68:69], s56, v195
    s_or_b64 vcc, vcc, s[68:69]
    s_wqm_b64 exec, vcc
    s_cbranch_scc1 L_spin22
    s_mov_b64 exec, -1
    v_lshlrev_b32 v196, 16, v192
    v_lshlrev_b32 v198, 16, v194
    v_and_b32 v197, 0xffff0000, v192
    v_and_b32 v199, 0xffff0000, v194
    s_nop 0
    v_permlane32_swap_b32 v196, v198
    v_permlane32_swap_b32 v197, v199
    v_add_f32 v196, v196, v198
    v_add_f32 v197, v197, v199
    s_nop 1
    v_permlane16_swap_b32 v196, v197
    v_add_f32 v196, v196, v197
    s_nop 1
    v_add_f32_dpp v196, v196, v196 row_ror:8 row_mask:0xf bank_mask:0xf
    ds_write_b32 v10, v196 offset:5632
    s_waitcnt lgkmcnt(0)
    s_barrier
L_join:
    s_cmp_lt_u32 s31, 96
    s_cbranch_scc1 L_exit
    v_lshrrev_b32 v15, 2, v1
    v_lshlrev_b32 v15, 11, v15
    v_and_b32 v9, 3, v1
    v_lshl_add_u32 v15, v9, 4, v15
    s_lshl_b32 s100, s30, 7
    s_lshl_b32 s63, s3, 4
    s_add_u32 s100, s100, s63
    s_lshl_b32 s100, s100, 11
    s_sub_u32 s64, s31, 96
    s_lshl_b32 s63, s64, 6
    s_add_u32 s100, s100, s63
    s_add_u32 s100, s100, 786432
    buffer_load_dwordx4 v[192:195], v15, s[44:47], s100 offen sc1
    v_lshlrev_b32 v9, 4, v9
    v_lshrrev_b32 v10, 4, v1
    v_lshl_add_u32 v9, v10, 2, v9
    s_lshl_b32 s63, s3, 6
    v_add_u32 v9, s63, v9
    v_and_b32 v10, 7, v1
    v_lshlrev_b32 v11, 3, v10
    v_lshrrev_b32 v12, 1, v10
    v_and_b32 v10, 1, v10
    v_lshlrev_b32 v10, 2, v10
    v_lshl_add_u32 v10, v12, 4, v10
    s_lshl_b32 s63, s30, 10
    s_lshr_b32 s65, s64, 3
    s_lshl_b32 s65, s65, 8
    s_add_u32 s63, s63, s65
    s_and_b32 s65, s64, 3
    s_lshl_b32 s65, s65, 6
    s_add_u32 s63, s63, s65
    s_and_b32 s65, s64, 4
    s_lshl_b32 s65, s65, 1
    s_add_u32 s63, s63, s65
    v_add_u32 v10, s63, v10
    s_mov_b32 s62, 0
    s_branch L_chk25
L_spin24:
    buffer_load_dwordx4 v[192:195], v15, s[44:47], s100 offen sc1
    s_add_u32 s62, s62, 1
    s_cmp_gt_u32 s62, 2000000
    s_cbranch_scc1 L_bail
L_chk25:
    s_waitcnt vmcnt(0)
    v_cmp_ne_u32 vcc, s56, v193
    v_cmp_ne_u32 s[68:69], s56, v195
    s_or_b64 vcc, vcc, s[68:69]
    s_wqm_b64 exec, vcc
    s_cbranch_scc1 L_spin24
    s_mov_b64 exec, -1
    v_lshlrev_b32 v196, 16, v192
    v_lshlrev_b32 v198, 16, v194
    v_and_b32 v197, 0xffff0000, v192
    v_and_b32 v199, 0xffff0000, v194
    s_nop 0
    v_permlane32_swap_b32 v196, v198
    v_permlane32_swap_b32 v197, v199
    v_add_f32 v196, v196, v198
    v_add_f32 v197, v197, v199
    s_nop 1
    v_permlane16_swap_b32 v196, v197
    v_add_f32 v196, v196, v197
    s_nop 1
    v_add_f32_dpp v196, v196, v196 row_ror:4 row_mask:0xf bank_mask:0xf
    s_nop 1
    v_add_f32_dpp v196, v196, v196 row_ror:8 row_mask:0xf bank_mask:0xf
    ds_write_b32 v9, v196 offset:5888
    s_waitcnt lgkmcnt(0)
    s_barrier
    s_cmp_lg_u32 s3, 0
    s_cbranch_scc1 L_exit
    ds_read_b64 v[64:65], v11 offset:5888
    ds_read_b64 v[66:67], v11 offset:5952
    ds_read_b64 v[68:69], v11 offset:6016
    ds_read_b64 v[70:71], v11 offset:6080
    ds_read_b64 v[72:73], v11 offset:6144
    ds_read_b64 v[74:75], v11 offset:6208
    ds_read_b64 v[76:77], v11 offset:6272
    ds_read_b64 v[78:79], v11 offset:6336
    s_waitcnt lgkmcnt(4)
    v_pk_add_f32 v[64:65], v[64:65], v[66:67]
    v_pk_add_f32 v[68:69], v[68:69], v[70:71]
    v_pk_add_f32 v[64:65], v[64:65], v[68:69]
    s_waitcnt lgkmcnt(0)
    v_pk_add_f32 v[72:73], v[72:73], v[74:75]
    v_pk_add_f32 v[76:77], v[76:77], v[78:79]
    v_pk_add_f32 v[72:73], v[72:73], v[76:77]
    v_pk_add_f32 v[64:65], v[64:65], v[72:73]
    s_mov_b64 exec, 0xff
    v_cvt_pk_bf16_f32 v64, v64, v65
    global_store_dword v10, v64, s[24:25]
    s_mov_b64 exec, -1
L_exit:
    s_endpgm
L_bail:
    s_mov_b64 exec, 1
    v_mov_b32 v9, 0
    v_mov_b32 v10, 0xdead
    global_store_dword v9, v10, s[26:27]
L_end:
    s_endpgm
.section .rodata,"a"
.p2align 6
.amdhsa_kernel gated_mix__gqa_block_cached__glu_gated_glu__decode_kernel
  .amdhsa_next_free_vgpr 256
  .amdhsa_next_free_sgpr 102
  .amdhsa_accum_offset 256
  .amdhsa_group_segment_fixed_size 0
  .amdhsa_kernarg_size 104
  .amdhsa_user_sgpr_count 2
  .amdhsa_user_sgpr_kernarg_segment_ptr 1
  .amdhsa_system_sgpr_workgroup_id_x 1
.end_amdhsa_kernel
```
